```python
import torch

def _softmax(x, axis=-1):
    return torch.softmax(x, dim=axis)
def _gelu(x):
    return torch.nn.functional.gelu(x, approximate="tanh")
def _silu(x):
    return torch.nn.functional.silu(x)
def _sigmoid(x):
    return torch.sigmoid(x)
def _layernorm(x, axis=-1, eps=1e-5):
    m = x.mean(dim=axis, keepdim=True)
    v = x.var(dim=axis, keepdim=True, unbiased=False)
    return (x - m) / torch.sqrt(v + eps)
def _scatter_add(tgt, idx, src, axis=0):
    return tgt.clone().index_add_(axis, idx, src)
def _segment_sum(src, seg, n):
    out = torch.zeros((n,) + src.shape[1:], dtype=src.dtype)
    return out.index_add_(0, seg, src)
def _pad(x, pw):
    flat = tuple(v for pair in reversed(pw) for v in pair)
    return torch.nn.functional.pad(x, flat)

kernel_name = 'concat_heads__gqa_block_cached__sliding_block_cached__decode'

def setup_inputs():

    _w = (lambda a: (lambda t: t.to(torch.bfloat16) if t.is_floating_point() else t)(torch.as_tensor(a)))
    def _A_setup():
        B, Sq, D = 4, 1, 1024
        Hq, Hkv, Sk, Dh = 32, 4, 8192, 128
        assert Hq % Hkv == 0, (Hq, Hkv)
        return {
            "x": _w((lambda *s: torch.randn(*s, dtype=torch.bfloat16) * 0.8)(B, Sq, D)),
            "k_cache": _w((lambda *s: torch.randn(*s, dtype=torch.bfloat16) * 1.6)(B, Hkv, Sk, Dh)),
            "v_cache": _w((lambda *s: torch.randn(*s, dtype=torch.bfloat16) * 0.2)(B, Hkv, Sk, Dh)),
            "wq": _w((lambda *s: torch.randn(*s, dtype=torch.bfloat16) * 1.6)(D, Hq * Dh) * (D ** -0.5)),
            "wo": _w((lambda *s: torch.randn(*s, dtype=torch.bfloat16) * 0.2)(Hq * Dh, D) * ((Hq * Dh) ** -0.5)),
        }
    _A_in = _A_setup()

    def _B_setup():
        B, Sq, D = 4, 1, 1024
        Hq, Hkv, Sk, Dh = 32, 4, 8192, 128
        assert Hq % Hkv == 0, (Hq, Hkv)
        return {
            "x": _w((lambda *s: torch.randn(*s, dtype=torch.bfloat16) * 0.8)(B, Sq, D)),
            "k_cache": _w((lambda *s: torch.randn(*s, dtype=torch.bfloat16) * 1.6)(B, Hkv, Sk, Dh)),
            "v_cache": _w((lambda *s: torch.randn(*s, dtype=torch.bfloat16) * 0.2)(B, Hkv, Sk, Dh)),
            "wq": _w((lambda *s: torch.randn(*s, dtype=torch.bfloat16) * 1.6)(D, Hq * Dh) * (D ** -0.5)),
            "wo": _w((lambda *s: torch.randn(*s, dtype=torch.bfloat16) * 0.2)(Hq * Dh, D) * ((Hq * Dh) ** -0.5)),
        }
    _B_in = _B_setup()

    return {
        "A_x": _A_in["x"],
        "A_k_cache": _A_in["k_cache"],
        "A_v_cache": _A_in["v_cache"],
        "A_wq": _A_in["wq"],
        "A_wo": _A_in["wo"],
        "B_x": _B_in["x"],
        "B_k_cache": _B_in["k_cache"],
        "B_v_cache": _B_in["v_cache"],
        "B_wq": _B_in["wq"],
        "B_wo": _B_in["wo"],
    }

def reference(A_x, A_k_cache, A_v_cache, A_wq, A_wo, B_x, B_k_cache, B_v_cache, B_wq, B_wo):
    def _A_ref(x, k_cache, v_cache, wq, wo):
        B, Sq, D = x.shape
        Hq, Dh = 32, 128
        Hkv = k_cache.shape[1]
        rep = Hq // Hkv
        q = (lambda x, *d: x.permute(*d))((x @ wq).reshape(B, Sq, Hq, Dh), 0, 2, 1, 3)
        k = (lambda x, n, axis: torch.repeat_interleave(x, n, dim=axis))(k_cache, rep, axis=1)
        v = (lambda x, n, axis: torch.repeat_interleave(x, n, dim=axis))(v_cache, rep, axis=1)
        scores = torch.einsum("bhqd,bhkd->bhqk", q, k) * (Dh ** -0.5)
        p = _softmax(scores, axis=-1)
        o = torch.einsum("bhqk,bhkd->bhqd", p, v)
        return (lambda x, *d: x.permute(*d))(o, 0, 2, 1, 3).reshape(B, Sq, Hq * Dh) @ wo

    def _B_ref(x, k_cache, v_cache, wq, wo):
        B, Sq, D = x.shape
        Hq, Dh = 32, 128
        Hkv, Sk = k_cache.shape[1], k_cache.shape[2]
        W = min(4096, max(256, Sk // 4))
        rep = Hq // Hkv
        q = (lambda x, *d: x.permute(*d))((x @ wq).reshape(B, Sq, Hq, Dh), 0, 2, 1, 3)
        k = (lambda x, n, axis: torch.repeat_interleave(x, n, dim=axis))(k_cache[:, :, Sk - W:, :], rep, axis=1)
        v = (lambda x, n, axis: torch.repeat_interleave(x, n, dim=axis))(v_cache[:, :, Sk - W:, :], rep, axis=1)
        scores = torch.einsum("bhqd,bhkd->bhqk", q, k) * (Dh ** -0.5)
        p = _softmax(scores, axis=-1)
        o = torch.einsum("bhqk,bhkd->bhqd", p, v)
        return (lambda x, *d: x.permute(*d))(o, 0, 2, 1, 3).reshape(B, Sq, Hq * Dh) @ wo

    a = _A_ref(A_x, A_k_cache, A_v_cache, A_wq, A_wo)
    b = _B_ref(B_x, B_k_cache, B_v_cache, B_wq, B_wo)
    return torch.concatenate([a, b], axis=-1)
```

```asm
; @launch grid=(256,1,1) block=(256,1,1) lds=59904
.amdgcn_target "amdgcn-amd-amdhsa--gfx950"
.text
.globl concat_heads__gqa_block_cached__sliding_block_cached__decode_kernel
.p2align 8
.type concat_heads__gqa_block_cached__sliding_block_cached__decode_kernel,@function
concat_heads__gqa_block_cached__sliding_block_cached__decode_kernel:
s_cmp_ge_u32 s2, 256
s_cbranch_scc1 L_done
s_load_dwordx16 s[4:19], s[0:1], 0
s_load_dwordx8 s[20:27], s[0:1], 64
s_load_dwordx2 s[28:29], s[0:1], 96
s_getpc_b64 s[100:101]
s_getreg_b32 s3, hwreg(HW_REG_HW_ID, 8, 2)
s_lshl_b32 s3, s3, 12
v_lshrrev_b32 v3, 6, v0
v_lshl_add_u32 v9, v0, 4, s3
global_load_dwordx4 v[124:127], v9, s[100:101]
v_readfirstlane_b32 s3, v3
v_and_b32 v1, 63, v0
v_lshrrev_b32 v3, 4, v1
v_and_b32 v2, 15, v1
v_lshlrev_b32 v2, 4, v2
v_lshl_add_u32 v6, v3, 16, v2
s_bfe_u32 s67, s2, 0x20005
s_lshl_b32 s67, s67, 8
s_lshl_b32 s68, s3, 6
s_add_u32 s67, s67, s68
s_lshl_b32 s30, s67, 13
s_and_b32 s68, s2, 31
s_lshl_b32 s68, s68, 8
s_add_u32 s30, s30, s68
s_mov_b32 s50, 0x800000
s_mov_b32 s51, 0x20000
s_cmp_ge_u32 s2, 128
s_waitcnt lgkmcnt(0)
s_cselect_b32 s48, s20, s10
s_cselect_b32 s49, s21, s11
s_cselect_b32 s60, s14, s4
s_cselect_b32 s61, s15, s5
s_and_b32 s49, s49, 0xffff
s_add_u32 s64, s30, 0
buffer_load_dwordx4 v[128:131], v6, s[48:51], s64 offen nt
s_add_u32 s64, s30, 8192
buffer_load_dwordx4 v[132:135], v6, s[48:51], s64 offen nt
s_add_u32 s64, s30, 16384
buffer_load_dwordx4 v[136:139], v6, s[48:51], s64 offen nt
s_add_u32 s64, s30, 24576
buffer_load_dwordx4 v[140:143], v6, s[48:51], s64 offen nt
s_add_u32 s64, s30, 32768
buffer_load_dwordx4 v[144:147], v6, s[48:51], s64 offen nt
s_add_u32 s64, s30, 40960
buffer_load_dwordx4 v[148:151], v6, s[48:51], s64 offen nt
s_add_u32 s64, s30, 49152
buffer_load_dwordx4 v[152:155], v6, s[48:51], s64 offen nt
s_add_u32 s64, s30, 57344
buffer_load_dwordx4 v[156:159], v6, s[48:51], s64 offen nt
s_add_u32 s64, s30, 262144
buffer_load_dwordx4 v[160:163], v6, s[48:51], s64 offen nt
s_add_u32 s64, s30, 270336
buffer_load_dwordx4 v[164:167], v6, s[48:51], s64 offen nt
s_add_u32 s64, s30, 278528
buffer_load_dwordx4 v[168:171], v6, s[48:51], s64 offen nt
s_add_u32 s64, s30, 286720
buffer_load_dwordx4 v[172:175], v6, s[48:51], s64 offen nt
s_add_u32 s64, s30, 294912
buffer_load_dwordx4 v[176:179], v6, s[48:51], s64 offen nt
s_add_u32 s64, s30, 303104
buffer_load_dwordx4 v[180:183], v6, s[48:51], s64 offen nt
s_add_u32 s64, s30, 311296
buffer_load_dwordx4 v[184:187], v6, s[48:51], s64 offen nt
s_add_u32 s64, s30, 319488
buffer_load_dwordx4 v[188:191], v6, s[48:51], s64 offen nt
s_and_b32 s61, s61, 0xffff
s_mov_b32 s62, 8192
s_mov_b32 s63, 0x20000
v_and_b32 v11, 3, v1
v_lshlrev_b32 v11, 11, v11
v_lshl_add_u32 v11, v3, 4, v11
s_lshl_b32 s68, s67, 1
buffer_load_dwordx4 v[56:59], v11, s[60:63], s68 offen
buffer_load_dwordx4 v[60:63], v11, s[60:63], s68 offen offset:64
s_lshr_b32 s67, s2, 5
s_lshl_b32 s67, s67, 2
s_add_u32 s67, s67, s3
s_lshl_b32 s67, s67, 5
s_and_b32 s68, s2, 31
s_add_u32 s67, s67, s68
s_lshl_b32 s4, s67, 9
s_and_b32 s67, s2, 7
s_lshl_b32 s67, s67, 5
s_lshr_b32 s2, s2, 3
s_add_u32 s2, s2, s67
s_and_b32 s0, s2, 15
s_mov_b32 s32, s6
s_mov_b32 s33, s7
s_mov_b32 s36, s8
s_mov_b32 s37, s9
s_mov_b32 s40, s16
s_mov_b32 s41, s17
s_mov_b32 s44, s18
s_mov_b32 s45, s19
s_mov_b32 s66, 1572864
s_cmp_ge_u32 s2, 128
s_cselect_b32 s52, s22, s12
s_cselect_b32 s53, s23, s13
s_and_b32 s33, s33, 0xffff
s_mov_b32 s34, 33554432
s_mov_b32 s35, 0x20000
s_and_b32 s37, s37, 0xffff
s_mov_b32 s38, 33554432
s_mov_b32 s39, 0x20000
s_and_b32 s41, s41, 0xffff
s_mov_b32 s42, 33554432
s_mov_b32 s43, 0x20000
s_and_b32 s45, s45, 0xffff
s_mov_b32 s46, 33554432
s_mov_b32 s47, 0x20000
s_and_b32 s53, s53, 0xffff
s_mov_b32 s54, 0x800000
s_mov_b32 s55, 0x20000
s_mov_b32 s56, s28
s_and_b32 s57, s29, 0xffff
s_mov_b32 s58, 5243008
s_mov_b32 s59, 0x20000
s_add_u32 s12, s28, 5242880
s_addc_u32 s13, s29, 0
s_load_dword s11, s[12:13], 0
s_lshr_b32 s67, s2, 4
s_lshl_b32 s67, s67, 21
s_lshl_b32 s65, s0, 17
s_add_u32 s65, s65, s67
s_lshl_b32 s64, s3, 13
s_add_u32 s65, s65, s64
s_add_u32 s66, s66, s67
s_lshl_b32 s64, s0, 15
s_add_u32 s66, s66, s64
s_lshl_b32 s64, s3, 13
s_add_u32 s66, s66, s64
v_lshl_add_u32 v5, v3, 9, v2
v_bfe_u32 v2, v1, 1, 3
v_lshlrev_b32 v4, 8, v2
v_lshl_add_u32 v4, v3, 5, v4
v_and_b32 v2, 1, v1
v_lshl_add_u32 v4, v2, 4, v4
s_add_u32 s10, s65, 0
buffer_load_dwordx4 a[0:3], v4, s[32:35], s10 offen offset:0 nt
buffer_load_dwordx4 a[4:7], v4, s[32:35], s10 offen offset:128 nt
buffer_load_dwordx4 a[8:11], v4, s[32:35], s10 offen offset:2048 nt
buffer_load_dwordx4 a[12:15], v4, s[32:35], s10 offen offset:2176 nt
v_and_b32 v7, 7, v1
v_lshlrev_b32 v7, 4, v7
v_lshl_add_u32 v7, v3, 14, v7
v_bfe_u32 v8, v1, 3, 1
v_lshl_add_u32 v7, v8, 16, v7
v_lshlrev_b32 v8, 4, v1
s_bfe_u32 s67, s2, 0x50002
s_lshl_b32 s31, s67, 18
s_lshl_b32 s68, s3, 7
s_add_u32 s31, s31, s68
s_and_b32 s68, s2, 3
s_lshl_b32 s68, s68, 9
s_add_u32 s31, s31, s68
s_mov_b32 s69, 0x05040100
s_mov_b32 s70, 0x07060302
v_lshlrev_b32 v10, 3, v1
s_add_u32 s10, s65, 4096
buffer_load_dwordx4 a[16:19], v4, s[32:35], s10 offen offset:0 nt
buffer_load_dwordx4 a[20:23], v4, s[32:35], s10 offen offset:128 nt
buffer_load_dwordx4 a[24:27], v4, s[32:35], s10 offen offset:2048 nt
buffer_load_dwordx4 a[28:31], v4, s[32:35], s10 offen offset:2176 nt
s_waitcnt lgkmcnt(0)
s_mul_i32 s14, s11, 1
s_add_u32 s14, s14, 1
s_and_b32 s14, s14, 0xff
s_mul_i32 s15, s11, 3
s_add_u32 s15, s15, 91
s_and_b32 s15, s15, 0xff
s_mul_i32 s16, s11, 5
s_add_u32 s16, s16, 167
s_and_b32 s16, s16, 0xff
s_mul_i32 s17, s11, 7
s_add_u32 s17, s17, 61
s_and_b32 s17, s17, 0xff
s_lshl_b32 s18, s15, 8
s_or_b32 s18, s18, s14
s_lshl_b32 s19, s16, 16
s_or_b32 s22, s18, s19
s_lshl_b32 s19, s17, 24
s_or_b32 s18, s22, s19
s_mov_b32 s19, 0x0c0c0400
s_mov_b32 s20, 0x0c040100
s_mov_b32 s21, 0x04020100
s_waitcnt vmcnt(8)
v_mov_b32 v127, 0xff
v_perm_b32 v64, v132, v128, s69
v_perm_b32 v65, v140, v136, s69
v_perm_b32 v66, v148, v144, s69
v_perm_b32 v67, v156, v152, s69
v_perm_b32 v68, v132, v128, s70
v_perm_b32 v69, v140, v136, s70
v_perm_b32 v70, v148, v144, s70
v_perm_b32 v71, v156, v152, s70
s_nop 1
v_mfma_f32_16x16x32_bf16 v[16:19], v[64:67], v[56:59], 0
v_mfma_f32_16x16x32_bf16 v[20:23], v[68:71], v[56:59], 0
v_perm_b32 v64, v133, v129, s69
v_perm_b32 v65, v141, v137, s69
v_perm_b32 v66, v149, v145, s69
v_perm_b32 v67, v157, v153, s69
v_perm_b32 v68, v133, v129, s70
v_perm_b32 v69, v141, v137, s70
v_perm_b32 v70, v149, v145, s70
v_perm_b32 v71, v157, v153, s70
s_nop 1
v_mfma_f32_16x16x32_bf16 v[24:27], v[64:67], v[56:59], 0
v_mfma_f32_16x16x32_bf16 v[28:31], v[68:71], v[56:59], 0
s_add_u32 s10, s65, 32768
buffer_load_dwordx4 a[32:35], v4, s[32:35], s10 offen offset:0 nt
v_perm_b32 v64, v134, v130, s69
v_perm_b32 v65, v142, v138, s69
v_perm_b32 v66, v150, v146, s69
v_perm_b32 v67, v158, v154, s69
v_perm_b32 v68, v134, v130, s70
v_perm_b32 v69, v142, v138, s70
v_perm_b32 v70, v150, v146, s70
v_perm_b32 v71, v158, v154, s70
s_nop 1
v_mfma_f32_16x16x32_bf16 v[32:35], v[64:67], v[56:59], 0
v_mfma_f32_16x16x32_bf16 v[36:39], v[68:71], v[56:59], 0
v_perm_b32 v64, v135, v131, s69
v_perm_b32 v65, v143, v139, s69
v_perm_b32 v66, v151, v147, s69
v_perm_b32 v67, v159, v155, s69
v_perm_b32 v68, v135, v131, s70
v_perm_b32 v69, v143, v139, s70
v_perm_b32 v70, v151, v147, s70
v_perm_b32 v71, v159, v155, s70
s_nop 1
v_mfma_f32_16x16x32_bf16 v[40:43], v[64:67], v[56:59], 0
v_mfma_f32_16x16x32_bf16 v[44:47], v[68:71], v[56:59], 0
v_perm_b32 v64, v164, v160, s69
v_perm_b32 v65, v172, v168, s69
v_perm_b32 v66, v180, v176, s69
v_perm_b32 v67, v188, v184, s69
v_perm_b32 v68, v164, v160, s70
v_perm_b32 v69, v172, v168, s70
v_perm_b32 v70, v180, v176, s70
v_perm_b32 v71, v188, v184, s70
s_nop 1
v_mfma_f32_16x16x32_bf16 v[16:19], v[64:67], v[60:63], v[16:19]
v_mfma_f32_16x16x32_bf16 v[20:23], v[68:71], v[60:63], v[20:23]
buffer_load_dwordx4 a[36:39], v4, s[32:35], s10 offen offset:128 nt
v_perm_b32 v64, v165, v161, s69
v_perm_b32 v65, v173, v169, s69
v_perm_b32 v66, v181, v177, s69
v_perm_b32 v67, v189, v185, s69
v_perm_b32 v68, v165, v161, s70
v_perm_b32 v69, v173, v169, s70
v_perm_b32 v70, v181, v177, s70
v_perm_b32 v71, v189, v185, s70
s_nop 1
v_mfma_f32_16x16x32_bf16 v[24:27], v[64:67], v[60:63], v[24:27]
v_mfma_f32_16x16x32_bf16 v[28:31], v[68:71], v[60:63], v[28:31]
v_perm_b32 v64, v166, v162, s69
v_perm_b32 v65, v174, v170, s69
v_perm_b32 v66, v182, v178, s69
v_perm_b32 v67, v190, v186, s69
v_perm_b32 v68, v166, v162, s70
v_perm_b32 v69, v174, v170, s70
v_perm_b32 v70, v182, v178, s70
v_perm_b32 v71, v190, v186, s70
s_nop 1
v_mfma_f32_16x16x32_bf16 v[32:35], v[64:67], v[60:63], v[32:35]
v_mfma_f32_16x16x32_bf16 v[36:39], v[68:71], v[60:63], v[36:39]
v_perm_b32 v64, v167, v163, s69
v_perm_b32 v65, v175, v171, s69
v_perm_b32 v66, v183, v179, s69
v_perm_b32 v67, v191, v187, s69
v_perm_b32 v68, v167, v163, s70
v_perm_b32 v69, v175, v171, s70
v_perm_b32 v70, v183, v179, s70
v_perm_b32 v71, v191, v187, s70
s_nop 1
v_mfma_f32_16x16x32_bf16 v[40:43], v[64:67], v[60:63], v[40:43]
v_mfma_f32_16x16x32_bf16 v[44:47], v[68:71], v[60:63], v[44:47]
buffer_load_dwordx4 a[40:43], v4, s[32:35], s10 offen offset:2048 nt
v_and_b32 v2, 3, v1
v_mul_u32_u24 v2, 528, v2
v_lshl_add_u32 v2, v3, 7, v2
s_mul_i32 s67, s3, 2112
v_add_u32 v2, s67, v2
s_nop 1
s_mov_b32 exec_lo, 0x000f000f
s_mov_b32 exec_hi, 0x000f000f
ds_write_b128 v2, v[16:19] offset:0
ds_write_b128 v2, v[20:23] offset:16
ds_write_b128 v2, v[24:27] offset:32
ds_write_b128 v2, v[28:31] offset:48
ds_write_b128 v2, v[32:35] offset:64
ds_write_b128 v2, v[36:39] offset:80
ds_write_b128 v2, v[40:43] offset:96
ds_write_b128 v2, v[44:47] offset:112
s_mov_b64 exec, -1
s_mul_i32 s67, s3, 528
v_add_u32 v2, s67, v10
v_and_b32 v56, 1, v1
v_lshlrev_b32 v56, 4, v56
v_lshrrev_b32 v56, v56, s18
v_lshrrev_b32 v57, 8, v56
buffer_load_dwordx4 a[44:47], v4, s[32:35], s10 offen offset:2176 nt
s_waitcnt lgkmcnt(0)
s_barrier
ds_read_b64 v[16:17], v2 offset:0
ds_read_b64 v[18:19], v2 offset:2112
ds_read_b64 v[20:21], v2 offset:4224
ds_read_b64 v[22:23], v2 offset:6336
s_waitcnt lgkmcnt(0)
v_add_f32 v16, v16, v18
v_add_f32 v17, v17, v19
v_add_f32 v20, v20, v22
v_add_f32 v21, v21, v23
v_add_f32 v16, v16, v20
v_add_f32 v17, v17, v21
v_bfi_b32 v16, v127, v56, v16
v_bfi_b32 v17, v127, v57, v17
buffer_store_dwordx2 v[16:17], v10, s[56:59], s4 offen sc1
s_lshr_b32 s67, s2, 6
s_lshl_b32 s67, s67, 5
s_bfe_u32 s68, s2, 0x20004
s_lshl_b32 s68, s68, 3
s_add_u32 s67, s67, s68
s_lshl_b32 s68, s3, 1
s_add_u32 s67, s67, s68
s_lshl_b32 s9, s67, 9
v_lshrrev_b32 v2, 5, v1
v_lshlrev_b32 v2, 8, v2
v_bfe_u32 v9, v1, 3, 2
v_lshl_add_u32 v2, v9, 6, v2
v_and_b32 v9, 7, v1
v_lshl_add_u32 v11, v9, 1, v2
s_lshl_b32 s67, s3, 9
v_add_u32 v2, s67, v11
s_add_u32 s10, s65, 36864
s_waitcnt vmcnt(11)
buffer_load_dwordx4 a[48:51], v4, s[32:35], s10 offen offset:0 nt
s_waitcnt vmcnt(11)
buffer_load_dwordx4 a[52:55], v4, s[32:35], s10 offen offset:128 nt
s_waitcnt vmcnt(11)
buffer_load_dwordx4 a[56:59], v4, s[32:35], s10 offen offset:2048 nt
s_waitcnt vmcnt(11)
buffer_load_dwordx4 a[60:63], v4, s[32:35], s10 offen offset:2176 nt
s_add_u32 s10, s65, 65536
s_waitcnt vmcnt(11)
buffer_load_dwordx4 a[64:67], v4, s[32:35], s10 offen offset:0 nt
s_waitcnt vmcnt(11)
buffer_load_dwordx4 a[68:71], v4, s[32:35], s10 offen offset:128 nt
s_waitcnt vmcnt(11)
buffer_load_dwordx4 a[72:75], v4, s[32:35], s10 offen offset:2048 nt
s_waitcnt vmcnt(11)
buffer_load_dwordx4 a[76:79], v4, s[32:35], s10 offen offset:2176 nt
s_add_u32 s10, s65, 69632
s_waitcnt vmcnt(11)
buffer_load_dwordx4 a[80:83], v4, s[32:35], s10 offen offset:0 nt
s_waitcnt vmcnt(11)
buffer_load_dwordx4 a[84:87], v4, s[32:35], s10 offen offset:128 nt
s_waitcnt vmcnt(11)
buffer_load_dwordx4 a[88:91], v4, s[32:35], s10 offen offset:2048 nt
buffer_load_dwordx4 a[92:95], v4, s[32:35], s10 offen offset:2176 nt
s_add_u32 s10, s65, 98304
buffer_load_dwordx4 a[96:99], v4, s[32:35], s10 offen offset:0 nt
buffer_load_dwordx4 a[100:103], v4, s[32:35], s10 offen offset:128 nt
buffer_load_dwordx4 a[104:107], v4, s[32:35], s10 offen offset:2048 nt
buffer_load_dwordx4 a[108:111], v4, s[32:35], s10 offen offset:2176 nt
s_add_u32 s10, s65, 102400
buffer_load_dwordx4 a[112:115], v4, s[32:35], s10 offen offset:0 nt
buffer_load_dwordx4 a[116:119], v4, s[32:35], s10 offen offset:128 nt
buffer_load_dwordx4 a[120:123], v4, s[32:35], s10 offen offset:2048 nt
buffer_load_dwordx4 a[124:127], v4, s[32:35], s10 offen offset:2176 nt
s_add_u32 s64, s9, 0
buffer_load_dwordx4 v[16:19], v8, s[56:59], s64 offen sc1
s_add_u32 s64, s9, 65536
buffer_load_dwordx4 v[20:23], v8, s[56:59], s64 offen sc1
s_add_u32 s64, s9, 131072
buffer_load_dwordx4 v[24:27], v8, s[56:59], s64 offen sc1
s_add_u32 s64, s9, 196608
buffer_load_dwordx4 v[28:31], v8, s[56:59], s64 offen sc1
s_add_u32 s64, s9, 262144
buffer_load_dwordx4 v[32:35], v8, s[56:59], s64 offen sc1
s_add_u32 s64, s9, 327680
buffer_load_dwordx4 v[36:39], v8, s[56:59], s64 offen sc1
s_add_u32 s64, s9, 393216
buffer_load_dwordx4 v[40:43], v8, s[56:59], s64 offen sc1
s_add_u32 s64, s9, 458752
buffer_load_dwordx4 v[44:47], v8, s[56:59], s64 offen sc1
s_add_u32 s10, s66, 0
s_waitcnt vmcnt(11)
buffer_load_dwordx4 a[128:131], v4, s[40:43], s10 offen offset:0 nt
s_waitcnt vmcnt(11)
buffer_load_dwordx4 a[132:135], v4, s[40:43], s10 offen offset:128 nt
s_add_u32 s10, s66, 0
s_waitcnt vmcnt(11)
buffer_load_dwordx4 a[136:139], v4, s[40:43], s10 offen offset:2048 nt
s_waitcnt vmcnt(11)
buffer_load_dwordx4 a[140:143], v4, s[40:43], s10 offen offset:2176 nt
s_add_u32 s10, s66, 4096
s_waitcnt vmcnt(11)
buffer_load_dwordx4 a[144:147], v4, s[40:43], s10 offen offset:0 nt
s_waitcnt vmcnt(11)
buffer_load_dwordx4 a[148:151], v4, s[40:43], s10 offen offset:128 nt
s_add_u32 s10, s66, 4096
s_waitcnt vmcnt(11)
buffer_load_dwordx4 a[152:155], v4, s[40:43], s10 offen offset:2048 nt
s_waitcnt vmcnt(11)
buffer_load_dwordx4 a[156:159], v4, s[40:43], s10 offen offset:2176 nt
s_waitcnt vmcnt(8)
s_mov_b32 s71, 1000000
L_qpoll:
v_perm_b32 v92, v17, v16, s19
v_perm_b32 v92, v18, v92, s20
v_perm_b32 v92, v19, v92, s21
v_xor_b32 v92, s18, v92
v_perm_b32 v93, v21, v20, s19
v_perm_b32 v93, v22, v93, s20
v_perm_b32 v93, v23, v93, s21
v_xor_b32 v93, s18, v93
v_perm_b32 v94, v25, v24, s19
v_perm_b32 v94, v26, v94, s20
v_perm_b32 v94, v27, v94, s21
v_xor_b32 v94, s18, v94
v_perm_b32 v95, v29, v28, s19
v_perm_b32 v95, v30, v95, s20
v_perm_b32 v95, v31, v95, s21
v_xor_b32 v95, s18, v95
v_perm_b32 v96, v33, v32, s19
v_perm_b32 v96, v34, v96, s20
v_perm_b32 v96, v35, v96, s21
v_xor_b32 v96, s18, v96
v_perm_b32 v97, v37, v36, s19
v_perm_b32 v97, v38, v97, s20
v_perm_b32 v97, v39, v97, s21
v_xor_b32 v97, s18, v97
v_perm_b32 v98, v41, v40, s19
v_perm_b32 v98, v42, v98, s20
v_perm_b32 v98, v43, v98, s21
v_xor_b32 v98, s18, v98
v_perm_b32 v99, v45, v44, s19
v_perm_b32 v99, v46, v99, s20
v_perm_b32 v99, v47, v99, s21
v_xor_b32 v99, s18, v99
v_or3_b32 v92, v92, v93, v94
v_or3_b32 v95, v95, v96, v97
v_or3_b32 v92, v92, v98, v99
v_or_b32 v92, v92, v95
v_cmp_ne_u32 vcc, 0, v92
s_nop 1
s_cmp_eq_u64 vcc, 0
s_cbranch_scc1 L_qok
s_sub_u32 s71, s71, 1
s_cmp_eq_u32 s71, 0
s_cbranch_scc1 L_qok
s_add_u32 s64, s9, 0
buffer_load_dwordx4 v[16:19], v8, s[56:59], s64 offen sc1
s_add_u32 s64, s9, 65536
buffer_load_dwordx4 v[20:23], v8, s[56:59], s64 offen sc1
s_add_u32 s64, s9, 131072
buffer_load_dwordx4 v[24:27], v8, s[56:59], s64 offen sc1
s_add_u32 s64, s9, 196608
buffer_load_dwordx4 v[28:31], v8, s[56:59], s64 offen sc1
s_add_u32 s64, s9, 262144
buffer_load_dwordx4 v[32:35], v8, s[56:59], s64 offen sc1
s_add_u32 s64, s9, 327680
buffer_load_dwordx4 v[36:39], v8, s[56:59], s64 offen sc1
s_add_u32 s64, s9, 393216
buffer_load_dwordx4 v[40:43], v8, s[56:59], s64 offen sc1
s_add_u32 s64, s9, 458752
buffer_load_dwordx4 v[44:47], v8, s[56:59], s64 offen sc1
s_waitcnt vmcnt(0)
s_branch L_qpoll
L_qok:
v_add_f32 v16, v16, v20
v_add_f32 v24, v24, v28
s_add_u32 s10, s66, 0
buffer_load_dwordx4 a[160:163], v5, s[44:47], s10 offen offset:0 nt
v_add_f32 v17, v17, v21
v_add_f32 v25, v25, v29
v_add_f32 v18, v18, v22
v_add_f32 v26, v26, v30
v_add_f32 v19, v19, v23
v_add_f32 v27, v27, v31
v_add_f32 v16, v16, v24
v_add_f32 v17, v17, v25
v_add_f32 v18, v18, v26
v_add_f32 v19, v19, v27
v_cvt_pk_bf16_f32 v20, v16, v17
v_cvt_pk_bf16_f32 v21, v18, v19
ds_write_b16 v2, v20 offset:8704
ds_write_b16_d16_hi v2, v20 offset:8720
ds_write_b16 v2, v21 offset:8736
ds_write_b16_d16_hi v2, v21 offset:8752
v_add_f32 v32, v32, v36
v_add_f32 v40, v40, v44
v_add_f32 v33, v33, v37
v_add_f32 v41, v41, v45
v_add_f32 v34, v34, v38
v_add_f32 v42, v42, v46
v_add_f32 v35, v35, v39
v_add_f32 v43, v43, v47
v_add_f32 v32, v32, v40
v_add_f32 v33, v33, v41
v_add_f32 v34, v34, v42
v_add_f32 v35, v35, v43
v_cvt_pk_bf16_f32 v36, v32, v33
v_cvt_pk_bf16_f32 v37, v34, v35
ds_write_b16 v2, v36 offset:10752
ds_write_b16_d16_hi v2, v36 offset:10768
ds_write_b16 v2, v37 offset:10784
ds_write_b16_d16_hi v2, v37 offset:10800
buffer_load_dwordx4 a[164:167], v5, s[44:47], s10 offen offset:256 nt
s_waitcnt lgkmcnt(0)
s_barrier
ds_read_b128 v[56:59], v4 offset:8704
ds_read_b128 v[64:67], v4 offset:10752
ds_read_b128 v[60:63], v4 offset:8832
ds_read_b128 v[68:71], v4 offset:10880
s_mov_b32 s4, 0xaaaaaaaa
s_mov_b32 s5, 0xaaaaaaaa
s_mov_b32 s6, 0x3db504f3
s_mov_b32 s7, 0x3fb8aa3b
s_add_u32 s10, s66, 0
buffer_load_dwordx4 a[168:171], v5, s[44:47], s10 offen offset:2048 nt
buffer_load_dwordx4 a[172:175], v5, s[44:47], s10 offen offset:2304 nt
s_add_u32 s10, s66, 4096
s_waitcnt vmcnt(11)
buffer_load_dwordx4 a[176:179], v5, s[44:47], s10 offen offset:0 nt
s_waitcnt vmcnt(11)
buffer_load_dwordx4 a[180:183], v5, s[44:47], s10 offen offset:256 nt
s_add_u32 s10, s66, 4096
s_waitcnt vmcnt(11)
buffer_load_dwordx4 a[184:187], v5, s[44:47], s10 offen offset:2048 nt
s_waitcnt vmcnt(11)
buffer_load_dwordx4 a[188:191], v5, s[44:47], s10 offen offset:2304 nt
s_add_u32 s10, s65, 0
s_waitcnt vmcnt(11)
buffer_load_dwordx4 a[192:195], v5, s[36:39], s10 offen offset:0 nt
s_waitcnt vmcnt(11)
buffer_load_dwordx4 a[196:199], v5, s[36:39], s10 offen offset:256 nt
s_waitcnt vmcnt(11)
buffer_load_dwordx4 a[200:203], v5, s[36:39], s10 offen offset:2048 nt
s_waitcnt vmcnt(11)
s_waitcnt lgkmcnt(0)
v_mfma_f32_16x16x32_bf16 v[92:95], a[0:3], v[56:59], 0
v_mfma_f32_16x16x32_bf16 v[96:99], a[8:11], v[56:59], 0
v_mfma_f32_16x16x32_bf16 v[100:103], a[16:19], v[56:59], 0
v_mfma_f32_16x16x32_bf16 v[104:107], a[24:27], v[56:59], 0
v_mfma_f32_16x16x32_bf16 v[92:95], a[4:7], v[60:63], v[92:95]
v_mfma_f32_16x16x32_bf16 v[96:99], a[12:15], v[60:63], v[96:99]
v_mfma_f32_16x16x32_bf16 v[100:103], a[20:23], v[60:63], v[100:103]
v_mfma_f32_16x16x32_bf16 v[104:107], a[28:31], v[60:63], v[104:107]
v_mfma_f32_16x16x32_bf16 v[108:111], a[32:35], v[56:59], 0
v_mfma_f32_16x16x32_bf16 v[112:115], a[40:43], v[56:59], 0
v_mfma_f32_16x16x32_bf16 v[116:119], a[48:51], v[56:59], 0
v_mfma_f32_16x16x32_bf16 v[120:123], a[56:59], v[56:59], 0
v_mfma_f32_16x16x32_bf16 v[108:111], a[36:39], v[60:63], v[108:111]
v_mfma_f32_16x16x32_bf16 v[112:115], a[44:47], v[60:63], v[112:115]
v_mfma_f32_16x16x32_bf16 v[116:119], a[52:55], v[60:63], v[116:119]
v_mfma_f32_16x16x32_bf16 v[120:123], a[60:63], v[60:63], v[120:123]
v_cndmask_b32 v16, v92, v93, s[4:5]
buffer_load_dwordx4 a[204:207], v5, s[36:39], s10 offen offset:2304 nt
v_cndmask_b32 v17, v94, v95, s[4:5]
v_cndmask_b32 v18, v96, v97, s[4:5]
v_cndmask_b32 v19, v98, v99, s[4:5]
v_cndmask_b32 v20, v100, v101, s[4:5]
v_cndmask_b32 v21, v102, v103, s[4:5]
v_cndmask_b32 v22, v104, v105, s[4:5]
v_cndmask_b32 v23, v106, v107, s[4:5]
s_nop 1
v_add_f32_dpp v16, v16, v16 quad_perm:[1,0,3,2] row_mask:0xf bank_mask:0xf
v_add_f32_dpp v17, v17, v17 quad_perm:[1,0,3,2] row_mask:0xf bank_mask:0xf
v_add_f32_dpp v18, v18, v18 quad_perm:[1,0,3,2] row_mask:0xf bank_mask:0xf
v_add_f32_dpp v19, v19, v19 quad_perm:[1,0,3,2] row_mask:0xf bank_mask:0xf
v_add_f32_dpp v20, v20, v20 quad_perm:[1,0,3,2] row_mask:0xf bank_mask:0xf
v_add_f32_dpp v21, v21, v21 quad_perm:[1,0,3,2] row_mask:0xf bank_mask:0xf
v_add_f32_dpp v22, v22, v22 quad_perm:[1,0,3,2] row_mask:0xf bank_mask:0xf
v_add_f32_dpp v23, v23, v23 quad_perm:[1,0,3,2] row_mask:0xf bank_mask:0xf
v_cvt_pk_bf16_f32 v2, v16, v17
v_lshlrev_b32 v16, 16, v2
v_and_b32 v17, 0xffff0000, v2
v_mul_f32 v16, s6, v16
v_mul_f32 v17, s6, v17
v_cvt_pk_bf16_f32 v2, v16, v17
v_lshlrev_b32 v16, 16, v2
v_and_b32 v17, 0xffff0000, v2
v_cvt_pk_bf16_f32 v2, v18, v19
v_lshlrev_b32 v18, 16, v2
v_and_b32 v19, 0xffff0000, v2
v_mul_f32 v18, s6, v18
v_mul_f32 v19, s6, v19
v_cvt_pk_bf16_f32 v2, v18, v19
v_lshlrev_b32 v18, 16, v2
v_and_b32 v19, 0xffff0000, v2
v_cvt_pk_bf16_f32 v2, v20, v21
v_lshlrev_b32 v20, 16, v2
v_and_b32 v21, 0xffff0000, v2
v_mul_f32 v20, s6, v20
v_mul_f32 v21, s6, v21
v_cvt_pk_bf16_f32 v2, v20, v21
v_lshlrev_b32 v20, 16, v2
v_and_b32 v21, 0xffff0000, v2
v_cvt_pk_bf16_f32 v2, v22, v23
v_lshlrev_b32 v22, 16, v2
v_and_b32 v23, 0xffff0000, v2
v_mul_f32 v22, s6, v22
v_mul_f32 v23, s6, v23
v_cvt_pk_bf16_f32 v2, v22, v23
v_lshlrev_b32 v22, 16, v2
v_and_b32 v23, 0xffff0000, v2
s_add_u32 s10, s65, 4096
s_waitcnt vmcnt(11)
buffer_load_dwordx4 a[208:211], v5, s[36:39], s10 offen offset:0 nt
v_mfma_f32_16x16x32_bf16 v[92:95], a[64:67], v[56:59], 0
v_mfma_f32_16x16x32_bf16 v[96:99], a[72:75], v[56:59], 0
v_mfma_f32_16x16x32_bf16 v[100:103], a[80:83], v[56:59], 0
v_mfma_f32_16x16x32_bf16 v[104:107], a[88:91], v[56:59], 0
v_mfma_f32_16x16x32_bf16 v[92:95], a[68:71], v[60:63], v[92:95]
v_mfma_f32_16x16x32_bf16 v[96:99], a[76:79], v[60:63], v[96:99]
v_mfma_f32_16x16x32_bf16 v[100:103], a[84:87], v[60:63], v[100:103]
v_mfma_f32_16x16x32_bf16 v[104:107], a[92:95], v[60:63], v[104:107]
v_cndmask_b32 v24, v108, v109, s[4:5]
v_cndmask_b32 v25, v110, v111, s[4:5]
v_cndmask_b32 v26, v112, v113, s[4:5]
v_cndmask_b32 v27, v114, v115, s[4:5]
v_cndmask_b32 v28, v116, v117, s[4:5]
v_cndmask_b32 v29, v118, v119, s[4:5]
v_cndmask_b32 v30, v120, v121, s[4:5]
v_cndmask_b32 v31, v122, v123, s[4:5]
s_nop 1
v_add_f32_dpp v24, v24, v24 quad_perm:[1,0,3,2] row_mask:0xf bank_mask:0xf
v_add_f32_dpp v25, v25, v25 quad_perm:[1,0,3,2] row_mask:0xf bank_mask:0xf
v_add_f32_dpp v26, v26, v26 quad_perm:[1,0,3,2] row_mask:0xf bank_mask:0xf
v_add_f32_dpp v27, v27, v27 quad_perm:[1,0,3,2] row_mask:0xf bank_mask:0xf
v_add_f32_dpp v28, v28, v28 quad_perm:[1,0,3,2] row_mask:0xf bank_mask:0xf
v_add_f32_dpp v29, v29, v29 quad_perm:[1,0,3,2] row_mask:0xf bank_mask:0xf
v_add_f32_dpp v30, v30, v30 quad_perm:[1,0,3,2] row_mask:0xf bank_mask:0xf
s_waitcnt vmcnt(11)
buffer_load_dwordx4 a[212:215], v5, s[36:39], s10 offen offset:256 nt
v_add_f32_dpp v31, v31, v31 quad_perm:[1,0,3,2] row_mask:0xf bank_mask:0xf
v_cvt_pk_bf16_f32 v2, v24, v25
v_lshlrev_b32 v24, 16, v2
v_and_b32 v25, 0xffff0000, v2
v_mul_f32 v24, s6, v24
v_mul_f32 v25, s6, v25
v_cvt_pk_bf16_f32 v2, v24, v25
v_lshlrev_b32 v24, 16, v2
v_and_b32 v25, 0xffff0000, v2
v_cvt_pk_bf16_f32 v2, v26, v27
v_lshlrev_b32 v26, 16, v2
v_and_b32 v27, 0xffff0000, v2
v_mul_f32 v26, s6, v26
v_mul_f32 v27, s6, v27
v_cvt_pk_bf16_f32 v2, v26, v27
v_lshlrev_b32 v26, 16, v2
v_and_b32 v27, 0xffff0000, v2
v_cvt_pk_bf16_f32 v2, v28, v29
v_lshlrev_b32 v28, 16, v2
v_and_b32 v29, 0xffff0000, v2
v_mul_f32 v28, s6, v28
v_mul_f32 v29, s6, v29
v_cvt_pk_bf16_f32 v2, v28, v29
v_lshlrev_b32 v28, 16, v2
v_and_b32 v29, 0xffff0000, v2
v_cvt_pk_bf16_f32 v2, v30, v31
v_lshlrev_b32 v30, 16, v2
v_and_b32 v31, 0xffff0000, v2
v_mul_f32 v30, s6, v30
v_mul_f32 v31, s6, v31
v_cvt_pk_bf16_f32 v2, v30, v31
v_lshlrev_b32 v30, 16, v2
v_and_b32 v31, 0xffff0000, v2
v_mfma_f32_16x16x32_bf16 v[108:111], a[96:99], v[56:59], 0
v_mfma_f32_16x16x32_bf16 v[112:115], a[104:107], v[56:59], 0
v_mfma_f32_16x16x32_bf16 v[116:119], a[112:115], v[56:59], 0
v_mfma_f32_16x16x32_bf16 v[120:123], a[120:123], v[56:59], 0
v_mfma_f32_16x16x32_bf16 v[108:111], a[100:103], v[60:63], v[108:111]
v_mfma_f32_16x16x32_bf16 v[112:115], a[108:111], v[60:63], v[112:115]
v_mfma_f32_16x16x32_bf16 v[116:119], a[116:119], v[60:63], v[116:119]
v_mfma_f32_16x16x32_bf16 v[120:123], a[124:127], v[60:63], v[120:123]
v_cndmask_b32 v32, v92, v93, s[4:5]
s_waitcnt vmcnt(11)
buffer_load_dwordx4 a[216:219], v5, s[36:39], s10 offen offset:2048 nt
v_cndmask_b32 v33, v94, v95, s[4:5]
v_cndmask_b32 v34, v96, v97, s[4:5]
v_cndmask_b32 v35, v98, v99, s[4:5]
v_cndmask_b32 v36, v100, v101, s[4:5]
v_cndmask_b32 v37, v102, v103, s[4:5]
v_cndmask_b32 v38, v104, v105, s[4:5]
v_cndmask_b32 v39, v106, v107, s[4:5]
s_nop 1
v_add_f32_dpp v32, v32, v32 quad_perm:[1,0,3,2] row_mask:0xf bank_mask:0xf
v_add_f32_dpp v33, v33, v33 quad_perm:[1,0,3,2] row_mask:0xf bank_mask:0xf
v_add_f32_dpp v34, v34, v34 quad_perm:[1,0,3,2] row_mask:0xf bank_mask:0xf
v_add_f32_dpp v35, v35, v35 quad_perm:[1,0,3,2] row_mask:0xf bank_mask:0xf
v_add_f32_dpp v36, v36, v36 quad_perm:[1,0,3,2] row_mask:0xf bank_mask:0xf
v_add_f32_dpp v37, v37, v37 quad_perm:[1,0,3,2] row_mask:0xf bank_mask:0xf
v_add_f32_dpp v38, v38, v38 quad_perm:[1,0,3,2] row_mask:0xf bank_mask:0xf
v_add_f32_dpp v39, v39, v39 quad_perm:[1,0,3,2] row_mask:0xf bank_mask:0xf
v_cvt_pk_bf16_f32 v2, v32, v33
v_lshlrev_b32 v32, 16, v2
v_and_b32 v33, 0xffff0000, v2
v_mul_f32 v32, s6, v32
v_mul_f32 v33, s6, v33
v_cvt_pk_bf16_f32 v2, v32, v33
v_lshlrev_b32 v32, 16, v2
v_and_b32 v33, 0xffff0000, v2
v_cvt_pk_bf16_f32 v2, v34, v35
v_lshlrev_b32 v34, 16, v2
v_and_b32 v35, 0xffff0000, v2
v_mul_f32 v34, s6, v34
v_mul_f32 v35, s6, v35
v_cvt_pk_bf16_f32 v2, v34, v35
v_lshlrev_b32 v34, 16, v2
v_and_b32 v35, 0xffff0000, v2
v_cvt_pk_bf16_f32 v2, v36, v37
v_lshlrev_b32 v36, 16, v2
v_and_b32 v37, 0xffff0000, v2
v_mul_f32 v36, s6, v36
v_mul_f32 v37, s6, v37
v_cvt_pk_bf16_f32 v2, v36, v37
v_lshlrev_b32 v36, 16, v2
v_and_b32 v37, 0xffff0000, v2
v_cvt_pk_bf16_f32 v2, v38, v39
v_lshlrev_b32 v38, 16, v2
v_and_b32 v39, 0xffff0000, v2
v_mul_f32 v38, s6, v38
v_mul_f32 v39, s6, v39
v_cvt_pk_bf16_f32 v2, v38, v39
v_lshlrev_b32 v38, 16, v2
v_and_b32 v39, 0xffff0000, v2
s_waitcnt vmcnt(11)
buffer_load_dwordx4 a[220:223], v5, s[36:39], s10 offen offset:2304 nt
v_mfma_f32_16x16x32_bf16 v[92:95], a[128:131], v[64:67], 0
v_mfma_f32_16x16x32_bf16 v[96:99], a[136:139], v[64:67], 0
v_mfma_f32_16x16x32_bf16 v[100:103], a[144:147], v[64:67], 0
v_mfma_f32_16x16x32_bf16 v[104:107], a[152:155], v[64:67], 0
v_mfma_f32_16x16x32_bf16 v[92:95], a[132:135], v[68:71], v[92:95]
v_mfma_f32_16x16x32_bf16 v[96:99], a[140:143], v[68:71], v[96:99]
v_mfma_f32_16x16x32_bf16 v[100:103], a[148:151], v[68:71], v[100:103]
v_mfma_f32_16x16x32_bf16 v[104:107], a[156:159], v[68:71], v[104:107]
v_cndmask_b32 v40, v108, v109, s[4:5]
v_cndmask_b32 v41, v110, v111, s[4:5]
v_cndmask_b32 v42, v112, v113, s[4:5]
v_cndmask_b32 v43, v114, v115, s[4:5]
v_cndmask_b32 v44, v116, v117, s[4:5]
v_cndmask_b32 v45, v118, v119, s[4:5]
v_cndmask_b32 v46, v120, v121, s[4:5]
v_cndmask_b32 v47, v122, v123, s[4:5]
s_nop 1
v_add_f32_dpp v40, v40, v40 quad_perm:[1,0,3,2] row_mask:0xf bank_mask:0xf
v_add_f32_dpp v41, v41, v41 quad_perm:[1,0,3,2] row_mask:0xf bank_mask:0xf
v_add_f32_dpp v42, v42, v42 quad_perm:[1,0,3,2] row_mask:0xf bank_mask:0xf
v_add_f32_dpp v43, v43, v43 quad_perm:[1,0,3,2] row_mask:0xf bank_mask:0xf
v_add_f32_dpp v44, v44, v44 quad_perm:[1,0,3,2] row_mask:0xf bank_mask:0xf
v_add_f32_dpp v45, v45, v45 quad_perm:[1,0,3,2] row_mask:0xf bank_mask:0xf
v_add_f32_dpp v46, v46, v46 quad_perm:[1,0,3,2] row_mask:0xf bank_mask:0xf
s_add_u32 s10, s65, 32768
s_waitcnt vmcnt(11)
buffer_load_dwordx4 a[224:227], v5, s[36:39], s10 offen offset:0 nt
v_add_f32_dpp v47, v47, v47 quad_perm:[1,0,3,2] row_mask:0xf bank_mask:0xf
v_cvt_pk_bf16_f32 v2, v40, v41
v_lshlrev_b32 v40, 16, v2
v_and_b32 v41, 0xffff0000, v2
v_mul_f32 v40, s6, v40
v_mul_f32 v41, s6, v41
v_cvt_pk_bf16_f32 v2, v40, v41
v_lshlrev_b32 v40, 16, v2
v_and_b32 v41, 0xffff0000, v2
v_cvt_pk_bf16_f32 v2, v42, v43
v_lshlrev_b32 v42, 16, v2
v_and_b32 v43, 0xffff0000, v2
v_mul_f32 v42, s6, v42
v_mul_f32 v43, s6, v43
v_cvt_pk_bf16_f32 v2, v42, v43
v_lshlrev_b32 v42, 16, v2
v_and_b32 v43, 0xffff0000, v2
v_cvt_pk_bf16_f32 v2, v44, v45
v_lshlrev_b32 v44, 16, v2
v_and_b32 v45, 0xffff0000, v2
v_mul_f32 v44, s6, v44
v_mul_f32 v45, s6, v45
v_cvt_pk_bf16_f32 v2, v44, v45
v_lshlrev_b32 v44, 16, v2
v_and_b32 v45, 0xffff0000, v2
v_cvt_pk_bf16_f32 v2, v46, v47
v_lshlrev_b32 v46, 16, v2
v_and_b32 v47, 0xffff0000, v2
v_mul_f32 v46, s6, v46
v_mul_f32 v47, s6, v47
v_cvt_pk_bf16_f32 v2, v46, v47
v_lshlrev_b32 v46, 16, v2
v_and_b32 v47, 0xffff0000, v2
s_nop 7
v_cndmask_b32 v48, v92, v93, s[4:5]
v_cndmask_b32 v49, v94, v95, s[4:5]
v_cndmask_b32 v50, v96, v97, s[4:5]
v_cndmask_b32 v51, v98, v99, s[4:5]
v_cndmask_b32 v52, v100, v101, s[4:5]
v_cndmask_b32 v53, v102, v103, s[4:5]
v_cndmask_b32 v54, v104, v105, s[4:5]
v_cndmask_b32 v55, v106, v107, s[4:5]
s_nop 1
v_add_f32_dpp v48, v48, v48 quad_perm:[1,0,3,2] row_mask:0xf bank_mask:0xf
v_add_f32_dpp v49, v49, v49 quad_perm:[1,0,3,2] row_mask:0xf bank_mask:0xf
v_add_f32_dpp v50, v50, v50 quad_perm:[1,0,3,2] row_mask:0xf bank_mask:0xf
v_add_f32_dpp v51, v51, v51 quad_perm:[1,0,3,2] row_mask:0xf bank_mask:0xf
v_add_f32_dpp v52, v52, v52 quad_perm:[1,0,3,2] row_mask:0xf bank_mask:0xf
v_add_f32_dpp v53, v53, v53 quad_perm:[1,0,3,2] row_mask:0xf bank_mask:0xf
s_waitcnt vmcnt(11)
buffer_load_dwordx4 a[228:231], v5, s[36:39], s10 offen offset:256 nt
v_add_f32_dpp v54, v54, v54 quad_perm:[1,0,3,2] row_mask:0xf bank_mask:0xf
v_add_f32_dpp v55, v55, v55 quad_perm:[1,0,3,2] row_mask:0xf bank_mask:0xf
v_cvt_pk_bf16_f32 v2, v48, v49
v_lshlrev_b32 v48, 16, v2
v_and_b32 v49, 0xffff0000, v2
v_mul_f32 v48, s6, v48
v_mul_f32 v49, s6, v49
v_cvt_pk_bf16_f32 v2, v48, v49
v_lshlrev_b32 v48, 16, v2
v_and_b32 v49, 0xffff0000, v2
v_cvt_pk_bf16_f32 v2, v50, v51
v_lshlrev_b32 v50, 16, v2
v_and_b32 v51, 0xffff0000, v2
v_mul_f32 v50, s6, v50
v_mul_f32 v51, s6, v51
v_cvt_pk_bf16_f32 v2, v50, v51
v_lshlrev_b32 v50, 16, v2
v_and_b32 v51, 0xffff0000, v2
v_cvt_pk_bf16_f32 v2, v52, v53
v_lshlrev_b32 v52, 16, v2
v_and_b32 v53, 0xffff0000, v2
v_mul_f32 v52, s6, v52
v_mul_f32 v53, s6, v53
v_cvt_pk_bf16_f32 v2, v52, v53
v_lshlrev_b32 v52, 16, v2
v_and_b32 v53, 0xffff0000, v2
v_cvt_pk_bf16_f32 v2, v54, v55
v_lshlrev_b32 v54, 16, v2
v_and_b32 v55, 0xffff0000, v2
v_mul_f32 v54, s6, v54
v_mul_f32 v55, s6, v55
v_cvt_pk_bf16_f32 v2, v54, v55
v_lshlrev_b32 v54, 16, v2
v_and_b32 v55, 0xffff0000, v2
v_max3_f32 v12, v16, v17, v18
v_max3_f32 v12, v12, v19, v20
v_max3_f32 v12, v12, v21, v22
v_max3_f32 v12, v12, v23, v24
v_max3_f32 v12, v12, v25, v26
v_max3_f32 v12, v12, v27, v28
v_max3_f32 v12, v12, v29, v30
v_max3_f32 v12, v12, v31, v32
v_max3_f32 v12, v12, v33, v34
v_max3_f32 v12, v12, v35, v36
v_max3_f32 v12, v12, v37, v38
v_max3_f32 v12, v12, v39, v40
v_max3_f32 v12, v12, v41, v42
v_max3_f32 v12, v12, v43, v44
s_waitcnt vmcnt(11)
buffer_load_dwordx4 a[232:235], v5, s[36:39], s10 offen offset:2048 nt
v_max3_f32 v12, v12, v45, v46
v_max_f32 v12, v12, v47
v_max3_f32 v13, v48, v49, v50
v_max3_f32 v13, v13, v51, v52
v_max3_f32 v13, v13, v53, v54
v_max_f32 v13, v13, v55
v_bfe_u32 v9, v1, 1, 3
v_lshlrev_b32 v9, 6, v9
v_lshl_add_u32 v2, v3, 2, v9
s_lshl_b32 s67, s3, 4
v_add_u32 v10, s67, v2
ds_write_b32 v10, v12 offset:12800
ds_write_b32 v10, v13 offset:13312
s_waitcnt vmcnt(11)
buffer_load_dwordx4 a[236:239], v5, s[36:39], s10 offen offset:2304 nt
s_waitcnt lgkmcnt(0)
s_barrier
ds_read_b128 v[92:95], v9 offset:12800
ds_read_b128 v[96:99], v9 offset:12816
ds_read_b128 v[100:103], v9 offset:12832
ds_read_b128 v[104:107], v9 offset:12848
ds_read_b128 v[108:111], v9 offset:13312
ds_read_b128 v[112:115], v9 offset:13328
ds_read_b128 v[116:119], v9 offset:13344
ds_read_b128 v[120:123], v9 offset:13360
s_add_u32 s10, s65, 36864
s_waitcnt vmcnt(11)
buffer_load_dwordx4 a[240:243], v5, s[36:39], s10 offen offset:0 nt
s_waitcnt lgkmcnt(0)
v_max3_f32 v12, v92, v93, v94
v_max3_f32 v12, v12, v95, v96
v_max3_f32 v12, v12, v97, v98
v_max3_f32 v12, v12, v99, v100
v_max3_f32 v12, v12, v101, v102
v_max3_f32 v12, v12, v103, v104
v_max3_f32 v12, v12, v105, v106
v_max_f32 v12, v12, v107
v_max3_f32 v13, v108, v109, v110
v_max3_f32 v13, v13, v111, v112
v_max3_f32 v13, v13, v113, v114
v_max3_f32 v13, v13, v115, v116
v_max3_f32 v13, v13, v117, v118
v_max3_f32 v13, v13, v119, v120
v_max3_f32 v13, v13, v121, v122
v_max_f32 v13, v13, v123
v_mul_f32 v56, s7, v12
v_mul_f32 v57, s7, v13
v_fma_f32 v16, v16, s7, -v56
v_fma_f32 v17, v17, s7, -v56
v_fma_f32 v18, v18, s7, -v56
v_fma_f32 v19, v19, s7, -v56
v_fma_f32 v20, v20, s7, -v56
v_fma_f32 v21, v21, s7, -v56
v_fma_f32 v22, v22, s7, -v56
v_fma_f32 v23, v23, s7, -v56
v_fma_f32 v24, v24, s7, -v56
v_fma_f32 v25, v25, s7, -v56
v_fma_f32 v26, v26, s7, -v56
v_fma_f32 v27, v27, s7, -v56
v_fma_f32 v28, v28, s7, -v56
v_fma_f32 v29, v29, s7, -v56
v_fma_f32 v30, v30, s7, -v56
v_fma_f32 v31, v31, s7, -v56
v_fma_f32 v32, v32, s7, -v56
v_fma_f32 v33, v33, s7, -v56
v_fma_f32 v34, v34, s7, -v56
v_fma_f32 v35, v35, s7, -v56
v_fma_f32 v36, v36, s7, -v56
v_fma_f32 v37, v37, s7, -v56
v_fma_f32 v38, v38, s7, -v56
v_fma_f32 v39, v39, s7, -v56
v_fma_f32 v40, v40, s7, -v56
v_fma_f32 v41, v41, s7, -v56
v_fma_f32 v42, v42, s7, -v56
v_fma_f32 v43, v43, s7, -v56
v_fma_f32 v44, v44, s7, -v56
s_waitcnt vmcnt(11)
buffer_load_dwordx4 a[244:247], v5, s[36:39], s10 offen offset:256 nt
v_fma_f32 v45, v45, s7, -v56
v_fma_f32 v46, v46, s7, -v56
v_fma_f32 v47, v47, s7, -v56
v_fma_f32 v48, v48, s7, -v57
v_fma_f32 v49, v49, s7, -v57
v_fma_f32 v50, v50, s7, -v57
v_fma_f32 v51, v51, s7, -v57
v_fma_f32 v52, v52, s7, -v57
v_fma_f32 v53, v53, s7, -v57
v_fma_f32 v54, v54, s7, -v57
v_fma_f32 v55, v55, s7, -v57
v_exp_f32 v16, v16
v_exp_f32 v17, v17
v_exp_f32 v18, v18
v_exp_f32 v19, v19
v_exp_f32 v20, v20
v_exp_f32 v21, v21
v_exp_f32 v22, v22
v_exp_f32 v23, v23
v_exp_f32 v24, v24
v_exp_f32 v25, v25
v_exp_f32 v26, v26
v_exp_f32 v27, v27
v_exp_f32 v28, v28
v_exp_f32 v29, v29
v_exp_f32 v30, v30
v_exp_f32 v31, v31
v_exp_f32 v32, v32
v_exp_f32 v33, v33
v_exp_f32 v34, v34
s_waitcnt vmcnt(11)
buffer_load_dwordx4 a[248:251], v5, s[36:39], s10 offen offset:2048 nt
v_exp_f32 v35, v35
v_exp_f32 v36, v36
v_exp_f32 v37, v37
v_exp_f32 v38, v38
v_exp_f32 v39, v39
v_exp_f32 v40, v40
v_exp_f32 v41, v41
v_exp_f32 v42, v42
v_exp_f32 v43, v43
v_exp_f32 v44, v44
v_exp_f32 v45, v45
v_exp_f32 v46, v46
v_exp_f32 v47, v47
v_exp_f32 v48, v48
v_exp_f32 v49, v49
v_exp_f32 v50, v50
v_exp_f32 v51, v51
v_exp_f32 v52, v52
v_exp_f32 v53, v53
v_exp_f32 v54, v54
v_exp_f32 v55, v55
s_nop 0
v_cvt_pk_bf16_f32 v72, v16, v17
v_cvt_pk_bf16_f32 v73, v18, v19
v_cvt_pk_bf16_f32 v74, v20, v21
v_cvt_pk_bf16_f32 v75, v22, v23
v_cvt_pk_bf16_f32 v76, v24, v25
s_waitcnt vmcnt(11)
buffer_load_dwordx4 a[252:255], v5, s[36:39], s10 offen offset:2304 nt
v_cvt_pk_bf16_f32 v77, v26, v27
v_cvt_pk_bf16_f32 v78, v28, v29
v_cvt_pk_bf16_f32 v79, v30, v31
v_cvt_pk_bf16_f32 v80, v32, v33
v_cvt_pk_bf16_f32 v81, v34, v35
v_cvt_pk_bf16_f32 v82, v36, v37
v_cvt_pk_bf16_f32 v83, v38, v39
v_cvt_pk_bf16_f32 v84, v40, v41
v_cvt_pk_bf16_f32 v85, v42, v43
v_cvt_pk_bf16_f32 v86, v44, v45
v_cvt_pk_bf16_f32 v87, v46, v47
v_cvt_pk_bf16_f32 v88, v48, v49
v_cvt_pk_bf16_f32 v89, v50, v51
v_cvt_pk_bf16_f32 v90, v52, v53
v_cvt_pk_bf16_f32 v91, v54, v55
v_add_f32 v14, v16, v17
v_add_f32 v14, v14, v18
v_add_f32 v14, v14, v19
v_add_f32 v14, v14, v20
v_add_f32 v14, v14, v21
v_add_f32 v14, v14, v22
v_add_f32 v14, v14, v23
v_add_f32 v14, v14, v24
v_add_f32 v14, v14, v25
v_add_f32 v14, v14, v26
v_add_f32 v14, v14, v27
v_add_f32 v14, v14, v28
v_add_f32 v14, v14, v29
v_add_f32 v14, v14, v30
v_add_f32 v14, v14, v31
v_add_f32 v14, v14, v32
v_add_f32 v14, v14, v33
v_add_f32 v14, v14, v34
v_add_f32 v14, v14, v35
v_add_f32 v14, v14, v36
v_add_f32 v14, v14, v37
v_add_f32 v14, v14, v38
v_add_f32 v14, v14, v39
v_add_f32 v14, v14, v40
v_add_f32 v14, v14, v41
v_add_f32 v14, v14, v42
v_add_f32 v14, v14, v43
v_add_f32 v14, v14, v44
v_add_f32 v14, v14, v45
v_add_f32 v14, v14, v46
v_add_f32 v14, v14, v47
v_add_f32 v15, v48, v49
v_add_f32 v15, v15, v50
s_add_u32 s10, s65, 65536
s_waitcnt vmcnt(11)
buffer_load_dwordx4 v[192:195], v5, s[36:39], s10 offen offset:0 nt
v_add_f32 v15, v15, v51
v_add_f32 v15, v15, v52
v_add_f32 v15, v15, v53
v_add_f32 v15, v15, v54
v_add_f32 v15, v15, v55
ds_write_b32 v10, v14 offset:13824
ds_write_b32 v10, v15 offset:14336
s_mov_b32 s4, s2
s_add_u32 s5, s2, 256
s_waitcnt lgkmcnt(0)
v_lshrrev_b32 v14, 6, v9
v_mul_u32_u24 v14, 528, v14
v_lshl_add_u32 v14, v3, 7, v14
s_mul_i32 s67, s3, 4224
v_add_u32 v14, s67, v14
v_lshrrev_b32 v15, 5, v0
v_lshlrev_b32 v15, 4, v15
v_lshl_add_u32 v15, v0, 4, v15
v_lshlrev_b32 v10, 4, v0
v_mov_b32 v124, s14
v_mov_b32 v125, s15
v_mov_b32 v126, s16
v_accvgpr_read_b32 v64, a160
v_accvgpr_read_b32 v65, a164
v_accvgpr_read_b32 v66, a168
v_accvgpr_read_b32 v67, a172
v_accvgpr_read_b32 v68, a176
v_accvgpr_read_b32 v69, a180
v_accvgpr_read_b32 v70, a184
v_accvgpr_read_b32 v71, a188
v_perm_b32 v56, v65, v64, s69
v_perm_b32 v57, v67, v66, s69
v_perm_b32 v58, v69, v68, s69
v_perm_b32 v59, v71, v70, s69
v_perm_b32 v60, v65, v64, s70
v_perm_b32 v61, v67, v66, s70
v_perm_b32 v62, v69, v68, s70
v_perm_b32 v63, v71, v70, s70
s_nop 1
v_mfma_f32_16x16x32_bf16 v[16:19], v[56:59], v[88:91], 0
v_mfma_f32_16x16x32_bf16 v[20:23], v[60:63], v[88:91], 0
v_accvgpr_read_b32 v64, a161
v_accvgpr_read_b32 v65, a165
v_accvgpr_read_b32 v66, a169
v_accvgpr_read_b32 v67, a173
v_accvgpr_read_b32 v68, a177
v_accvgpr_read_b32 v69, a181
v_accvgpr_read_b32 v70, a185
v_accvgpr_read_b32 v71, a189
v_perm_b32 v56, v65, v64, s69
v_perm_b32 v57, v67, v66, s69
v_perm_b32 v58, v69, v68, s69
v_perm_b32 v59, v71, v70, s69
v_perm_b32 v60, v65, v64, s70
v_perm_b32 v61, v67, v66, s70
v_perm_b32 v62, v69, v68, s70
v_perm_b32 v63, v71, v70, s70
s_nop 1
v_mfma_f32_16x16x32_bf16 v[24:27], v[56:59], v[88:91], 0
v_mfma_f32_16x16x32_bf16 v[28:31], v[60:63], v[88:91], 0
s_waitcnt vmcnt(11)
buffer_load_dwordx4 v[196:199], v5, s[36:39], s10 offen offset:256 nt
v_accvgpr_read_b32 v64, a162
v_accvgpr_read_b32 v65, a166
v_accvgpr_read_b32 v66, a170
v_accvgpr_read_b32 v67, a174
v_accvgpr_read_b32 v68, a178
v_accvgpr_read_b32 v69, a182
v_accvgpr_read_b32 v70, a186
v_accvgpr_read_b32 v71, a190
v_perm_b32 v56, v65, v64, s69
v_perm_b32 v57, v67, v66, s69
v_perm_b32 v58, v69, v68, s69
v_perm_b32 v59, v71, v70, s69
v_perm_b32 v60, v65, v64, s70
v_perm_b32 v61, v67, v66, s70
v_perm_b32 v62, v69, v68, s70
v_perm_b32 v63, v71, v70, s70
s_nop 1
v_mfma_f32_16x16x32_bf16 v[32:35], v[56:59], v[88:91], 0
v_mfma_f32_16x16x32_bf16 v[36:39], v[60:63], v[88:91], 0
v_accvgpr_read_b32 v64, a163
v_accvgpr_read_b32 v65, a167
v_accvgpr_read_b32 v66, a171
v_accvgpr_read_b32 v67, a175
v_accvgpr_read_b32 v68, a179
v_accvgpr_read_b32 v69, a183
v_accvgpr_read_b32 v70, a187
v_accvgpr_read_b32 v71, a191
v_perm_b32 v56, v65, v64, s69
v_perm_b32 v57, v67, v66, s69
v_perm_b32 v58, v69, v68, s69
v_perm_b32 v59, v71, v70, s69
v_perm_b32 v60, v65, v64, s70
v_perm_b32 v61, v67, v66, s70
v_perm_b32 v62, v69, v68, s70
v_perm_b32 v63, v71, v70, s70
s_nop 1
v_mfma_f32_16x16x32_bf16 v[40:43], v[56:59], v[88:91], 0
v_mfma_f32_16x16x32_bf16 v[44:47], v[60:63], v[88:91], 0
s_waitcnt vmcnt(11)
buffer_load_dwordx4 v[200:203], v5, s[36:39], s10 offen offset:2048 nt
s_waitcnt vmcnt(11)
v_accvgpr_read_b32 v64, a192
v_accvgpr_read_b32 v65, a196
v_accvgpr_read_b32 v66, a200
v_accvgpr_read_b32 v67, a204
v_accvgpr_read_b32 v68, a208
v_accvgpr_read_b32 v69, a212
v_accvgpr_read_b32 v70, a216
v_accvgpr_read_b32 v71, a220
v_perm_b32 v56, v65, v64, s69
v_perm_b32 v57, v67, v66, s69
v_perm_b32 v58, v69, v68, s69
v_perm_b32 v59, v71, v70, s69
v_perm_b32 v60, v65, v64, s70
v_perm_b32 v61, v67, v66, s70
v_perm_b32 v62, v69, v68, s70
v_perm_b32 v63, v71, v70, s70
s_nop 1
v_mfma_f32_16x16x32_bf16 v[92:95], v[56:59], v[72:75], 0
v_mfma_f32_16x16x32_bf16 v[96:99], v[60:63], v[72:75], 0
v_accvgpr_read_b32 v64, a193
v_accvgpr_read_b32 v65, a197
v_accvgpr_read_b32 v66, a201
v_accvgpr_read_b32 v67, a205
v_accvgpr_read_b32 v68, a209
v_accvgpr_read_b32 v69, a213
v_accvgpr_read_b32 v70, a217
v_accvgpr_read_b32 v71, a221
v_perm_b32 v56, v65, v64, s69
v_perm_b32 v57, v67, v66, s69
v_perm_b32 v58, v69, v68, s69
v_perm_b32 v59, v71, v70, s69
v_perm_b32 v60, v65, v64, s70
v_perm_b32 v61, v67, v66, s70
v_perm_b32 v62, v69, v68, s70
v_perm_b32 v63, v71, v70, s70
s_nop 1
v_mfma_f32_16x16x32_bf16 v[100:103], v[56:59], v[72:75], 0
v_mfma_f32_16x16x32_bf16 v[104:107], v[60:63], v[72:75], 0
buffer_load_dwordx4 v[204:207], v5, s[36:39], s10 offen offset:2304 nt
v_accvgpr_read_b32 v64, a194
v_accvgpr_read_b32 v65, a198
v_accvgpr_read_b32 v66, a202
v_accvgpr_read_b32 v67, a206
v_accvgpr_read_b32 v68, a210
v_accvgpr_read_b32 v69, a214
v_accvgpr_read_b32 v70, a218
v_accvgpr_read_b32 v71, a222
v_perm_b32 v56, v65, v64, s69
v_perm_b32 v57, v67, v66, s69
v_perm_b32 v58, v69, v68, s69
v_perm_b32 v59, v71, v70, s69
v_perm_b32 v60, v65, v64, s70
v_perm_b32 v61, v67, v66, s70
v_perm_b32 v62, v69, v68, s70
v_perm_b32 v63, v71, v70, s70
s_nop 1
v_mfma_f32_16x16x32_bf16 v[108:111], v[56:59], v[72:75], 0
v_mfma_f32_16x16x32_bf16 v[112:115], v[60:63], v[72:75], 0
v_accvgpr_read_b32 v64, a195
v_accvgpr_read_b32 v65, a199
v_accvgpr_read_b32 v66, a203
v_accvgpr_read_b32 v67, a207
v_accvgpr_read_b32 v68, a211
v_accvgpr_read_b32 v69, a215
v_accvgpr_read_b32 v70, a219
v_accvgpr_read_b32 v71, a223
v_perm_b32 v56, v65, v64, s69
v_perm_b32 v57, v67, v66, s69
v_perm_b32 v58, v69, v68, s69
v_perm_b32 v59, v71, v70, s69
v_perm_b32 v60, v65, v64, s70
v_perm_b32 v61, v67, v66, s70
v_perm_b32 v62, v69, v68, s70
v_perm_b32 v63, v71, v70, s70
s_nop 1
v_mfma_f32_16x16x32_bf16 v[116:119], v[56:59], v[72:75], 0
v_mfma_f32_16x16x32_bf16 v[120:123], v[60:63], v[72:75], 0
s_add_u32 s10, s65, 69632
s_waitcnt vmcnt(11)
buffer_load_dwordx4 v[208:211], v5, s[36:39], s10 offen offset:0 nt
s_waitcnt vmcnt(11)
buffer_load_dwordx4 v[212:215], v5, s[36:39], s10 offen offset:256 nt
s_lshl_b32 s67, s5, 12
s_add_u32 s67, s67, 1048576
s_mov_b32 exec_lo, 0x55555555
s_mov_b32 exec_hi, 0x55555555
s_nop 3
ds_write_b128 v14, v[16:19] offset:33280
ds_write_b128 v14, v[20:23] offset:33296
ds_write_b128 v14, v[24:27] offset:33312
ds_write_b128 v14, v[28:31] offset:33328
ds_write_b128 v14, v[32:35] offset:33344
ds_write_b128 v14, v[36:39] offset:33360
s_nop 1
ds_write_b128 v14, v[40:43] offset:33376
ds_write_b128 v14, v[44:47] offset:33392
s_mov_b64 exec, -1
s_waitcnt lgkmcnt(0)
s_barrier
ds_read_b128 v[56:59], v15 offset:33280
ds_read_b128 v[60:63], v15 offset:37504
ds_read_b128 v[64:67], v15 offset:41728
ds_read_b128 v[68:71], v15 offset:45952
s_waitcnt lgkmcnt(0)
v_add_f32 v56, v56, v60
v_add_f32 v64, v64, v68
v_add_f32 v57, v57, v61
v_add_f32 v65, v65, v69
v_add_f32 v58, v58, v62
v_add_f32 v66, v66, v70
v_add_f32 v59, v59, v63
v_add_f32 v67, v67, v71
v_add_f32 v56, v56, v64
v_add_f32 v57, v57, v65
v_add_f32 v58, v58, v66
v_add_f32 v59, v59, v67
v_bfi_b32 v56, v127, s14, v56
v_bfi_b32 v57, v127, s15, v57
v_bfi_b32 v58, v127, s16, v58
v_bfi_b32 v59, v127, s17, v59
v_accvgpr_write_b32 a0, v56
v_accvgpr_write_b32 a1, v57
v_accvgpr_write_b32 a2, v58
v_accvgpr_write_b32 a3, v59
v_lshl_add_u32 v32, v3, 9, v9
v_and_b32 v32, 0x3ff, v32
ds_read_b128 v[16:19], v32 offset:13824
ds_read_b128 v[20:23], v32 offset:13840
ds_read_b128 v[24:27], v32 offset:13856
ds_read_b128 v[28:31], v32 offset:13872
v_cmp_eq_u32 vcc, 1, v3
v_lshlrev_b32 v33, 2, v9
v_lshl_add_u32 v33, v3, 15, v33
v_cndmask_b32 v34, v12, v13, vcc
s_and_b32 s67, s4, 0x1f0
s_lshl_b32 s67, s67, 7
s_and_b32 s68, s4, 15
s_lshl_b32 s68, s68, 4
s_add_u32 s67, s67, s68
s_add_u32 s67, s67, 3145728
s_lshl_b32 s68, s3, 2
s_lshl_b32 s68, 0x00050005, s68
s_waitcnt lgkmcnt(0)
v_add_f32 v16, v16, v17
v_add_f32 v18, v18, v19
v_add_f32 v16, v16, v18
v_add_f32 v20, v20, v21
v_add_f32 v22, v22, v23
v_add_f32 v20, v20, v22
v_add_f32 v24, v24, v25
v_add_f32 v26, v26, v27
v_add_f32 v24, v24, v26
v_add_f32 v28, v28, v29
v_add_f32 v30, v30, v31
v_add_f32 v28, v28, v30
v_add_f32 v16, v16, v20
v_add_f32 v24, v24, v28
v_add_f32 v17, v16, v24
v_mov_b32 v19, v17
v_mov_b32 v16, v34
v_mov_b32 v18, v34
v_bfi_b32 v16, v127, s14, v16
v_bfi_b32 v17, v127, s15, v17
v_bfi_b32 v18, v127, s16, v18
v_bfi_b32 v19, v127, s17, v19
s_mov_b32 exec_lo, s68
s_mov_b32 exec_hi, 0
buffer_store_dwordx4 v[16:19], v33, s[56:59], s67 offen sc1
s_mov_b64 exec, -1
s_bfe_u32 s67, s2, 0x20005
s_lshl_b32 s68, s3, 2
s_add_u32 s67, s67, s68
s_lshl_b32 s67, s67, 4
s_and_b32 s68, s2, 128
s_lshl_b32 s68, s68, 1
s_add_u32 s67, s67, s68
s_waitcnt vmcnt(11)
buffer_load_dwordx4 v[216:219], v5, s[36:39], s10 offen offset:2048 nt
s_bfe_u32 s68, s2, 0x30002
s_lshl_b32 s8, s67, 7
s_lshl_b32 s64, s68, 8
s_add_u32 s8, s8, s64
s_add_u32 s8, s8, 3145728
s_lshl_b32 s9, s67, 12
s_lshl_b32 s64, s68, 9
s_add_u32 s9, s9, s64
s_add_u32 s9, s9, 1048576
s_lshl_b32 s6, s67, 4
s_add_u32 s6, s6, 3670016
v_and_b32 v48, 15, v1
v_lshrrev_b32 v55, 5, v1
v_xor_b32 v48, v48, v55
v_lshlrev_b32 v48, 4, v48
v_and_b32 v50, 31, v1
v_lshlrev_b32 v50, 4, v50
v_lshl_add_u32 v49, v55, 12, v50
v_and_b32 v54, 0xff, v11
s_lshl_b32 s67, s3, 8
v_add_u32 v54, s67, v54
v_and_b32 v55, 3, v1
v_lshlrev_b32 v51, 8, v55
v_lshl_add_u32 v51, v3, 4, v51
v_bfe_u32 v52, v1, 2, 1
v_lshl_add_u32 v51, v52, 6, v51
v_mul_u32_u24 v52, 272, v55
v_lshrrev_b32 v53, 1, v3
v_mul_u32_u24 v53, 1088, v53
v_add_u32 v52, v52, v53
v_and_b32 v53, 1, v3
v_lshl_add_u32 v52, v53, 7, v52
s_mul_i32 s67, s3, 2176
v_add_u32 v52, s67, v52
v_lshl_add_u32 v53, v3, 4, v8
v_add_u32 v53, s67, v53
s_lshl_b32 s23, s2, 12
s_lshl_b32 s67, s3, 10
s_add_u32 s23, s23, s67
s_add_u32 s23, s23, 4194304
s_and_b32 s63, s2, 128
s_and_b32 s67, s2, 3
s_lshl_b32 s67, s67, 5
s_add_u32 s63, s63, s67
s_bfe_u32 s67, s2, 0x50002
s_add_u32 s63, s63, s67
s_lshl_b32 s63, s63, 4
s_add_u32 s63, s63, 3686400
s_waitcnt vmcnt(11)
buffer_load_dwordx4 v[220:223], v5, s[36:39], s10 offen offset:2304 nt
s_add_u32 s10, s65, 98304
s_waitcnt vmcnt(11)
buffer_load_dwordx4 v[224:227], v5, s[36:39], s10 offen offset:0 nt
s_waitcnt vmcnt(11)
buffer_load_dwordx4 v[228:231], v5, s[36:39], s10 offen offset:256 nt
s_waitcnt vmcnt(11)
v_accvgpr_read_b32 v64, a224
v_accvgpr_read_b32 v65, a228
v_accvgpr_read_b32 v66, a232
v_accvgpr_read_b32 v67, a236
v_accvgpr_read_b32 v68, a240
v_accvgpr_read_b32 v69, a244
v_accvgpr_read_b32 v70, a248
v_accvgpr_read_b32 v71, a252
v_perm_b32 v56, v65, v64, s69
v_perm_b32 v57, v67, v66, s69
v_perm_b32 v58, v69, v68, s69
v_perm_b32 v59, v71, v70, s69
v_perm_b32 v60, v65, v64, s70
v_perm_b32 v61, v67, v66, s70
v_perm_b32 v62, v69, v68, s70
v_perm_b32 v63, v71, v70, s70
s_nop 1
v_mfma_f32_16x16x32_bf16 v[92:95], v[56:59], v[76:79], v[92:95]
v_mfma_f32_16x16x32_bf16 v[96:99], v[60:63], v[76:79], v[96:99]
v_accvgpr_read_b32 v64, a225
v_accvgpr_read_b32 v65, a229
v_accvgpr_read_b32 v66, a233
v_accvgpr_read_b32 v67, a237
v_accvgpr_read_b32 v68, a241
v_accvgpr_read_b32 v69, a245
v_accvgpr_read_b32 v70, a249
v_accvgpr_read_b32 v71, a253
v_perm_b32 v56, v65, v64, s69
v_perm_b32 v57, v67, v66, s69
v_perm_b32 v58, v69, v68, s69
v_perm_b32 v59, v71, v70, s69
v_perm_b32 v60, v65, v64, s70
v_perm_b32 v61, v67, v66, s70
v_perm_b32 v62, v69, v68, s70
v_perm_b32 v63, v71, v70, s70
s_nop 1
v_mfma_f32_16x16x32_bf16 v[100:103], v[56:59], v[76:79], v[100:103]
v_mfma_f32_16x16x32_bf16 v[104:107], v[60:63], v[76:79], v[104:107]
buffer_load_dwordx4 v[232:235], v5, s[36:39], s10 offen offset:2048 nt
v_accvgpr_read_b32 v64, a226
v_accvgpr_read_b32 v65, a230
v_accvgpr_read_b32 v66, a234
v_accvgpr_read_b32 v67, a238
v_accvgpr_read_b32 v68, a242
v_accvgpr_read_b32 v69, a246
v_accvgpr_read_b32 v70, a250
v_accvgpr_read_b32 v71, a254
v_perm_b32 v56, v65, v64, s69
v_perm_b32 v57, v67, v66, s69
v_perm_b32 v58, v69, v68, s69
v_perm_b32 v59, v71, v70, s69
v_perm_b32 v60, v65, v64, s70
v_perm_b32 v61, v67, v66, s70
v_perm_b32 v62, v69, v68, s70
v_perm_b32 v63, v71, v70, s70
s_nop 1
v_mfma_f32_16x16x32_bf16 v[108:111], v[56:59], v[76:79], v[108:111]
v_mfma_f32_16x16x32_bf16 v[112:115], v[60:63], v[76:79], v[112:115]
v_accvgpr_read_b32 v64, a227
v_accvgpr_read_b32 v65, a231
v_accvgpr_read_b32 v66, a235
v_accvgpr_read_b32 v67, a239
v_accvgpr_read_b32 v68, a243
v_accvgpr_read_b32 v69, a247
v_accvgpr_read_b32 v70, a251
v_accvgpr_read_b32 v71, a255
v_perm_b32 v56, v65, v64, s69
v_perm_b32 v57, v67, v66, s69
v_perm_b32 v58, v69, v68, s69
v_perm_b32 v59, v71, v70, s69
v_perm_b32 v60, v65, v64, s70
v_perm_b32 v61, v67, v66, s70
v_perm_b32 v62, v69, v68, s70
v_perm_b32 v63, v71, v70, s70
s_nop 1
v_mfma_f32_16x16x32_bf16 v[116:119], v[56:59], v[76:79], v[116:119]
v_mfma_f32_16x16x32_bf16 v[120:123], v[60:63], v[76:79], v[120:123]
s_waitcnt vmcnt(11)
buffer_load_dwordx4 v[236:239], v5, s[36:39], s10 offen offset:2304 nt
s_add_u32 s10, s65, 102400
s_waitcnt vmcnt(11)
buffer_load_dwordx4 v[240:243], v5, s[36:39], s10 offen offset:0 nt
s_waitcnt vmcnt(11)
buffer_load_dwordx4 v[244:247], v5, s[36:39], s10 offen offset:256 nt
s_waitcnt vmcnt(11)
buffer_load_dwordx4 v[248:251], v5, s[36:39], s10 offen offset:2048 nt
s_waitcnt vmcnt(11)
buffer_load_dwordx4 v[252:255], v5, s[36:39], s10 offen offset:2304 nt
buffer_load_dwordx4 v[88:91], v48, s[56:59], s8 offen sc1
s_add_u32 s10, s31, 0
s_waitcnt vmcnt(12)
buffer_load_dwordx4 v[128:131], v7, s[52:55], s10 offen offset:0 nt
buffer_load_dwordx4 v[132:135], v7, s[52:55], s10 offen offset:2048 nt
s_waitcnt vmcnt(11)
v_perm_b32 v56, v196, v192, s69
v_perm_b32 v57, v204, v200, s69
v_perm_b32 v58, v212, v208, s69
v_perm_b32 v59, v220, v216, s69
v_perm_b32 v60, v196, v192, s70
v_perm_b32 v61, v204, v200, s70
v_perm_b32 v62, v212, v208, s70
v_perm_b32 v63, v220, v216, s70
s_nop 1
v_mfma_f32_16x16x32_bf16 v[92:95], v[56:59], v[80:83], v[92:95]
v_mfma_f32_16x16x32_bf16 v[96:99], v[60:63], v[80:83], v[96:99]
v_perm_b32 v56, v197, v193, s69
v_perm_b32 v57, v205, v201, s69
v_perm_b32 v58, v213, v209, s69
v_perm_b32 v59, v221, v217, s69
v_perm_b32 v60, v197, v193, s70
v_perm_b32 v61, v205, v201, s70
v_perm_b32 v62, v213, v209, s70
v_perm_b32 v63, v221, v217, s70
s_nop 1
v_mfma_f32_16x16x32_bf16 v[100:103], v[56:59], v[80:83], v[100:103]
v_mfma_f32_16x16x32_bf16 v[104:107], v[60:63], v[80:83], v[104:107]
v_perm_b32 v56, v198, v194, s69
v_perm_b32 v57, v206, v202, s69
v_perm_b32 v58, v214, v210, s69
v_perm_b32 v59, v222, v218, s69
v_perm_b32 v60, v198, v194, s70
v_perm_b32 v61, v206, v202, s70
v_perm_b32 v62, v214, v210, s70
v_perm_b32 v63, v222, v218, s70
s_nop 1
v_mfma_f32_16x16x32_bf16 v[108:111], v[56:59], v[80:83], v[108:111]
v_mfma_f32_16x16x32_bf16 v[112:115], v[60:63], v[80:83], v[112:115]
s_add_u32 s10, s31, 4096
buffer_load_dwordx4 v[136:139], v7, s[52:55], s10 offen offset:0 nt
v_perm_b32 v56, v199, v195, s69
v_perm_b32 v57, v207, v203, s69
v_perm_b32 v58, v215, v211, s69
v_perm_b32 v59, v223, v219, s69
v_perm_b32 v60, v199, v195, s70
v_perm_b32 v61, v207, v203, s70
v_perm_b32 v62, v215, v211, s70
v_perm_b32 v63, v223, v219, s70
s_nop 1
v_mfma_f32_16x16x32_bf16 v[116:119], v[56:59], v[80:83], v[116:119]
v_mfma_f32_16x16x32_bf16 v[120:123], v[60:63], v[80:83], v[120:123]
s_waitcnt vmcnt(4)
s_cmp_lg_u32 s3, 0
s_cbranch_scc1 L_nopf0
s_lshl_b32 s67, s4, 4
s_add_u32 s67, s67, 3670016
s_mov_b64 exec, 1
buffer_store_dwordx3 v[124:126], v8, s[56:59], s67 offen sc1
s_add_u32 s67, s67, 4096
buffer_store_dwordx3 v[124:126], v8, s[56:59], s67 offen sc1
s_mov_b64 exec, -1
L_nopf0:
v_perm_b32 v56, v228, v224, s69
v_perm_b32 v57, v236, v232, s69
v_perm_b32 v58, v244, v240, s69
v_perm_b32 v59, v252, v248, s69
v_perm_b32 v60, v228, v224, s70
v_perm_b32 v61, v236, v232, s70
v_perm_b32 v62, v244, v240, s70
v_perm_b32 v63, v252, v248, s70
s_nop 1
v_mfma_f32_16x16x32_bf16 v[92:95], v[56:59], v[84:87], v[92:95]
v_mfma_f32_16x16x32_bf16 v[96:99], v[60:63], v[84:87], v[96:99]
v_perm_b32 v56, v229, v225, s69
v_perm_b32 v57, v237, v233, s69
v_perm_b32 v58, v245, v241, s69
v_perm_b32 v59, v253, v249, s69
v_perm_b32 v60, v229, v225, s70
v_perm_b32 v61, v237, v233, s70
v_perm_b32 v62, v245, v241, s70
v_perm_b32 v63, v253, v249, s70
s_nop 1
v_mfma_f32_16x16x32_bf16 v[100:103], v[56:59], v[84:87], v[100:103]
v_mfma_f32_16x16x32_bf16 v[104:107], v[60:63], v[84:87], v[104:107]
v_perm_b32 v56, v230, v226, s69
v_perm_b32 v57, v238, v234, s69
v_perm_b32 v58, v246, v242, s69
v_perm_b32 v59, v254, v250, s69
v_perm_b32 v60, v230, v226, s70
v_perm_b32 v61, v238, v234, s70
v_perm_b32 v62, v246, v242, s70
v_perm_b32 v63, v254, v250, s70
s_nop 1
v_mfma_f32_16x16x32_bf16 v[108:111], v[56:59], v[84:87], v[108:111]
v_mfma_f32_16x16x32_bf16 v[112:115], v[60:63], v[84:87], v[112:115]
v_perm_b32 v56, v231, v227, s69
v_perm_b32 v57, v239, v235, s69
v_perm_b32 v58, v247, v243, s69
v_perm_b32 v59, v255, v251, s69
v_perm_b32 v60, v231, v227, s70
v_perm_b32 v61, v239, v235, s70
v_perm_b32 v62, v247, v243, s70
v_perm_b32 v63, v255, v251, s70
s_nop 1
v_mfma_f32_16x16x32_bf16 v[116:119], v[56:59], v[84:87], v[116:119]
v_mfma_f32_16x16x32_bf16 v[120:123], v[60:63], v[84:87], v[120:123]
s_lshl_b32 s67, s4, 12
s_add_u32 s67, s67, 1048576
s_mov_b32 exec_lo, 0x55555555
s_mov_b32 exec_hi, 0x55555555
s_nop 3
ds_write_b128 v14, v[92:95] offset:16384
ds_write_b128 v14, v[96:99] offset:16400
ds_write_b128 v14, v[100:103] offset:16416
ds_write_b128 v14, v[104:107] offset:16432
ds_write_b128 v14, v[108:111] offset:16448
ds_write_b128 v14, v[112:115] offset:16464
s_nop 1
ds_write_b128 v14, v[116:119] offset:16480
ds_write_b128 v14, v[120:123] offset:16496
s_mov_b64 exec, -1
s_waitcnt lgkmcnt(0)
s_barrier
ds_read_b128 v[56:59], v15 offset:16384
ds_read_b128 v[60:63], v15 offset:20608
ds_read_b128 v[64:67], v15 offset:24832
ds_read_b128 v[68:71], v15 offset:29056
s_waitcnt lgkmcnt(0)
v_add_f32 v56, v56, v60
v_add_f32 v64, v64, v68
v_add_f32 v57, v57, v61
v_add_f32 v65, v65, v69
v_add_f32 v58, v58, v62
v_add_f32 v66, v66, v70
v_add_f32 v59, v59, v63
v_add_f32 v67, v67, v71
v_add_f32 v56, v56, v64
v_add_f32 v57, v57, v65
v_add_f32 v58, v58, v66
v_add_f32 v59, v59, v67
v_bfi_b32 v56, v127, s14, v56
v_bfi_b32 v57, v127, s15, v57
v_bfi_b32 v58, v127, s16, v58
v_bfi_b32 v59, v127, s17, v59
buffer_store_dwordx4 v[56:59], v10, s[56:59], s67 offen sc1
s_add_u32 s67, s67, 1048576
buffer_store_dwordx4 a[0:3], v10, s[56:59], s67 offen sc1
buffer_load_dwordx4 v[140:143], v7, s[52:55], s10 offen offset:2048 nt
s_add_u32 s10, s31, 8192
buffer_load_dwordx4 v[144:147], v7, s[52:55], s10 offen offset:0 nt
buffer_load_dwordx4 v[148:151], v7, s[52:55], s10 offen offset:2048 nt
s_add_u32 s10, s31, 12288
buffer_load_dwordx4 v[152:155], v7, s[52:55], s10 offen offset:0 nt
buffer_load_dwordx4 v[156:159], v7, s[52:55], s10 offen offset:2048 nt
s_add_u32 s10, s31, 131072
buffer_load_dwordx4 v[160:163], v7, s[52:55], s10 offen offset:0 nt
buffer_load_dwordx4 v[164:167], v7, s[52:55], s10 offen offset:2048 nt
s_add_u32 s10, s31, 135168
buffer_load_dwordx4 v[168:171], v7, s[52:55], s10 offen offset:0 nt
buffer_load_dwordx4 v[172:175], v7, s[52:55], s10 offen offset:2048 nt
s_add_u32 s10, s31, 139264
buffer_load_dwordx4 v[176:179], v7, s[52:55], s10 offen offset:0 nt
buffer_load_dwordx4 v[180:183], v7, s[52:55], s10 offen offset:2048 nt
s_add_u32 s10, s31, 143360
buffer_load_dwordx4 v[184:187], v7, s[52:55], s10 offen offset:0 nt
buffer_load_dwordx4 v[188:191], v7, s[52:55], s10 offen offset:2048 nt
s_add_u32 s64, s9, 0
buffer_load_dwordx4 v[192:195], v49, s[56:59], s64 offen sc1
s_add_u32 s64, s9, 8192
buffer_load_dwordx4 v[196:199], v49, s[56:59], s64 offen sc1
s_add_u32 s64, s9, 16384
buffer_load_dwordx4 v[200:203], v49, s[56:59], s64 offen sc1
s_add_u32 s64, s9, 24576
buffer_load_dwordx4 v[204:207], v49, s[56:59], s64 offen sc1
s_add_u32 s64, s9, 32768
buffer_load_dwordx4 v[208:211], v49, s[56:59], s64 offen sc1
s_add_u32 s64, s9, 40960
buffer_load_dwordx4 v[212:215], v49, s[56:59], s64 offen sc1
s_add_u32 s64, s9, 49152
buffer_load_dwordx4 v[216:219], v49, s[56:59], s64 offen sc1
s_add_u32 s64, s9, 57344
buffer_load_dwordx4 v[220:223], v49, s[56:59], s64 offen sc1
buffer_load_dwordx3 v[92:94], v48, s[56:59], s6 offen sc1
s_waitcnt vmcnt(17)
v_perm_b32 v56, v89, v88, s19
v_perm_b32 v56, v90, v56, s20
v_perm_b32 v56, v91, v56, s21
v_cmp_ne_u32 vcc, s18, v56
s_nop 1
s_cmp_eq_u64 vcc, 0
s_cselect_b32 s62, 1, 0
s_cbranch_scc0 L_mlskip
v_and_b32 v88, 0xffffff00, v88
v_mov_b32 v56, v88
s_nop 1
v_max_f32_dpp v56, v56, v56 row_ror:1 row_mask:0xf bank_mask:0xf
s_nop 1
v_max_f32_dpp v56, v56, v56 row_ror:2 row_mask:0xf bank_mask:0xf
s_nop 1
v_max_f32_dpp v56, v56, v56 row_ror:4 row_mask:0xf bank_mask:0xf
s_nop 1
v_max_f32_dpp v56, v56, v56 row_ror:8 row_mask:0xf bank_mask:0xf
v_sub_f32 v57, v88, v56
v_mul_f32 v57, s7, v57
v_exp_f32 v57, v57
s_nop 0
v_mul_f32 v58, v57, v89
s_nop 1
v_add_f32_dpp v58, v58, v58 row_ror:1 row_mask:0xf bank_mask:0xf
s_nop 1
v_add_f32_dpp v58, v58, v58 row_ror:2 row_mask:0xf bank_mask:0xf
s_nop 1
v_add_f32_dpp v58, v58, v58 row_ror:4 row_mask:0xf bank_mask:0xf
s_nop 1
v_add_f32_dpp v58, v58, v58 row_ror:8 row_mask:0xf bank_mask:0xf
v_rcp_f32 v58, v58
s_nop 0
v_mul_f32 v57, v57, v58
s_nop 1
v_mov_b32_dpp v72, v57 row_newbcast:0 row_mask:0xf bank_mask:0xf
v_mov_b32_dpp v73, v57 row_newbcast:2 row_mask:0xf bank_mask:0xf
v_mov_b32_dpp v74, v57 row_newbcast:4 row_mask:0xf bank_mask:0xf
v_mov_b32_dpp v75, v57 row_newbcast:6 row_mask:0xf bank_mask:0xf
v_mov_b32_dpp v76, v57 row_newbcast:8 row_mask:0xf bank_mask:0xf
v_mov_b32_dpp v77, v57 row_newbcast:10 row_mask:0xf bank_mask:0xf
v_mov_b32_dpp v78, v57 row_newbcast:12 row_mask:0xf bank_mask:0xf
v_mov_b32_dpp v79, v57 row_newbcast:14 row_mask:0xf bank_mask:0xf
L_mlskip:
v_perm_b32 v224, v132, v128, s69
v_perm_b32 v225, v140, v136, s69
v_perm_b32 v226, v148, v144, s69
v_perm_b32 v227, v156, v152, s69
v_perm_b32 v228, v132, v128, s70
v_perm_b32 v229, v140, v136, s70
v_perm_b32 v230, v148, v144, s70
v_perm_b32 v231, v156, v152, s70
v_perm_b32 v232, v133, v129, s69
v_perm_b32 v233, v141, v137, s69
v_perm_b32 v234, v149, v145, s69
v_perm_b32 v235, v157, v153, s69
v_perm_b32 v236, v133, v129, s70
v_perm_b32 v237, v141, v137, s70
v_perm_b32 v238, v149, v145, s70
v_perm_b32 v239, v157, v153, s70
v_perm_b32 v240, v134, v130, s69
v_perm_b32 v241, v142, v138, s69
v_perm_b32 v242, v150, v146, s69
v_perm_b32 v243, v158, v154, s69
v_perm_b32 v244, v134, v130, s70
v_perm_b32 v245, v142, v138, s70
v_perm_b32 v246, v150, v146, s70
v_perm_b32 v247, v158, v154, s70
v_perm_b32 v248, v135, v131, s69
v_perm_b32 v249, v143, v139, s69
v_perm_b32 v250, v151, v147, s69
v_perm_b32 v251, v159, v155, s69
v_perm_b32 v252, v135, v131, s70
v_perm_b32 v253, v143, v139, s70
v_perm_b32 v254, v151, v147, s70
v_perm_b32 v255, v159, v155, s70
s_waitcnt vmcnt(9)
v_perm_b32 v16, v164, v160, s69
v_perm_b32 v17, v172, v168, s69
v_perm_b32 v18, v180, v176, s69
v_perm_b32 v19, v188, v184, s69
v_perm_b32 v20, v164, v160, s70
v_perm_b32 v21, v172, v168, s70
v_perm_b32 v22, v180, v176, s70
v_perm_b32 v23, v188, v184, s70
v_perm_b32 v24, v165, v161, s69
v_perm_b32 v25, v173, v169, s69
v_perm_b32 v26, v181, v177, s69
v_perm_b32 v27, v189, v185, s69
v_perm_b32 v28, v165, v161, s70
v_perm_b32 v29, v173, v169, s70
v_perm_b32 v30, v181, v177, s70
v_perm_b32 v31, v189, v185, s70
v_perm_b32 v32, v166, v162, s69
v_perm_b32 v33, v174, v170, s69
v_perm_b32 v34, v182, v178, s69
v_perm_b32 v35, v190, v186, s69
v_perm_b32 v36, v166, v162, s70
v_perm_b32 v37, v174, v170, s70
v_perm_b32 v38, v182, v178, s70
v_perm_b32 v39, v190, v186, s70
v_perm_b32 v40, v167, v163, s69
v_perm_b32 v41, v175, v171, s69
v_perm_b32 v42, v183, v179, s69
v_perm_b32 v43, v191, v187, s69
v_perm_b32 v44, v167, v163, s70
v_perm_b32 v45, v175, v171, s70
v_perm_b32 v46, v183, v179, s70
v_perm_b32 v47, v191, v187, s70
s_mov_b32 s71, 1000000
s_cmp_eq_u32 s62, 1
s_cbranch_scc1 L_mlok2
L_mlpoll:
buffer_load_dwordx4 v[88:91], v48, s[56:59], s8 offen sc1
s_waitcnt vmcnt(0)
v_perm_b32 v56, v89, v88, s19
v_perm_b32 v56, v90, v56, s20
v_perm_b32 v56, v91, v56, s21
v_cmp_ne_u32 vcc, s18, v56
s_nop 1
s_cmp_eq_u64 vcc, 0
s_cbranch_scc1 L_mlok
s_sub_u32 s71, s71, 1
s_cmp_lg_u32 s71, 0
s_cbranch_scc1 L_mlpoll
L_mlok:
v_and_b32 v88, 0xffffff00, v88
v_mov_b32 v56, v88
s_nop 1
v_max_f32_dpp v56, v56, v56 row_ror:1 row_mask:0xf bank_mask:0xf
s_nop 1
v_max_f32_dpp v56, v56, v56 row_ror:2 row_mask:0xf bank_mask:0xf
s_nop 1
v_max_f32_dpp v56, v56, v56 row_ror:4 row_mask:0xf bank_mask:0xf
s_nop 1
v_max_f32_dpp v56, v56, v56 row_ror:8 row_mask:0xf bank_mask:0xf
v_sub_f32 v57, v88, v56
v_mul_f32 v57, s7, v57
v_exp_f32 v57, v57
s_nop 0
v_mul_f32 v58, v57, v89
s_nop 1
v_add_f32_dpp v58, v58, v58 row_ror:1 row_mask:0xf bank_mask:0xf
s_nop 1
v_add_f32_dpp v58, v58, v58 row_ror:2 row_mask:0xf bank_mask:0xf
s_nop 1
v_add_f32_dpp v58, v58, v58 row_ror:4 row_mask:0xf bank_mask:0xf
s_nop 1
v_add_f32_dpp v58, v58, v58 row_ror:8 row_mask:0xf bank_mask:0xf
v_rcp_f32 v58, v58
s_nop 0
v_mul_f32 v57, v57, v58
s_nop 1
v_mov_b32_dpp v72, v57 row_newbcast:0 row_mask:0xf bank_mask:0xf
v_mov_b32_dpp v73, v57 row_newbcast:2 row_mask:0xf bank_mask:0xf
v_mov_b32_dpp v74, v57 row_newbcast:4 row_mask:0xf bank_mask:0xf
v_mov_b32_dpp v75, v57 row_newbcast:6 row_mask:0xf bank_mask:0xf
v_mov_b32_dpp v76, v57 row_newbcast:8 row_mask:0xf bank_mask:0xf
v_mov_b32_dpp v77, v57 row_newbcast:10 row_mask:0xf bank_mask:0xf
v_mov_b32_dpp v78, v57 row_newbcast:12 row_mask:0xf bank_mask:0xf
v_mov_b32_dpp v79, v57 row_newbcast:14 row_mask:0xf bank_mask:0xf
L_mlok2:
s_mov_b32 s4, 0xff
s_mov_b32 s1, 0xff
s_cmp_eq_u32 s3, 0
s_cselect_b32 s5, 1, 0
s_waitcnt vmcnt(0)
v_perm_b32 v56, v193, v192, s19
v_perm_b32 v56, v194, v56, s20
v_perm_b32 v56, v195, v56, s21
v_xor_b32 v56, s18, v56
v_perm_b32 v57, v197, v196, s19
v_perm_b32 v57, v198, v57, s20
v_perm_b32 v57, v199, v57, s21
v_xor_b32 v57, s18, v57
v_perm_b32 v58, v201, v200, s19
v_perm_b32 v58, v202, v58, s20
v_perm_b32 v58, v203, v58, s21
v_xor_b32 v58, s18, v58
v_perm_b32 v59, v205, v204, s19
v_perm_b32 v59, v206, v59, s20
v_perm_b32 v59, v207, v59, s21
v_xor_b32 v59, s18, v59
v_perm_b32 v60, v209, v208, s19
v_perm_b32 v60, v210, v60, s20
v_perm_b32 v60, v211, v60, s21
v_xor_b32 v60, s18, v60
v_perm_b32 v61, v213, v212, s19
v_perm_b32 v61, v214, v61, s20
v_perm_b32 v61, v215, v61, s21
v_xor_b32 v61, s18, v61
v_perm_b32 v62, v217, v216, s19
v_perm_b32 v62, v218, v62, s20
v_perm_b32 v62, v219, v62, s21
v_xor_b32 v62, s18, v62
v_perm_b32 v63, v221, v220, s19
v_perm_b32 v63, v222, v63, s20
v_perm_b32 v63, v223, v63, s21
v_xor_b32 v63, s18, v63
v_or3_b32 v56, v56, v57, v58
v_or3_b32 v59, v59, v60, v61
v_or3_b32 v56, v56, v62, v63
v_or_b32 v56, v56, v59
v_cmp_ne_u32 vcc, 0, v56
s_nop 1
s_cmp_eq_u64 vcc, 0
s_cbranch_scc1 L_h1ok
L_h1poll:
s_bitcmp0_b32 s1, 0
s_cbranch_scc1 L_h1c0
v_perm_b32 v56, v193, v192, s19
v_perm_b32 v56, v194, v56, s20
v_perm_b32 v56, v195, v56, s21
v_cmp_ne_u32 vcc, s18, v56
s_nop 1
s_cmp_eq_u64 vcc, 0
s_cselect_b32 s0, 1, 0
s_andn2_b32 s4, s4, s0
L_h1c0:
s_bitcmp0_b32 s1, 1
s_cbranch_scc1 L_h1c1
v_perm_b32 v56, v197, v196, s19
v_perm_b32 v56, v198, v56, s20
v_perm_b32 v56, v199, v56, s21
v_cmp_ne_u32 vcc, s18, v56
s_nop 1
s_cmp_eq_u64 vcc, 0
s_cselect_b32 s0, 2, 0
s_andn2_b32 s4, s4, s0
L_h1c1:
s_bitcmp0_b32 s1, 2
s_cbranch_scc1 L_h1c2
v_perm_b32 v56, v201, v200, s19
v_perm_b32 v56, v202, v56, s20
v_perm_b32 v56, v203, v56, s21
v_cmp_ne_u32 vcc, s18, v56
s_nop 1
s_cmp_eq_u64 vcc, 0
s_cselect_b32 s0, 4, 0
s_andn2_b32 s4, s4, s0
L_h1c2:
s_bitcmp0_b32 s1, 3
s_cbranch_scc1 L_h1c3
v_perm_b32 v56, v205, v204, s19
v_perm_b32 v56, v206, v56, s20
v_perm_b32 v56, v207, v56, s21
v_cmp_ne_u32 vcc, s18, v56
s_nop 1
s_cmp_eq_u64 vcc, 0
s_cselect_b32 s0, 8, 0
s_andn2_b32 s4, s4, s0
L_h1c3:
s_bitcmp0_b32 s1, 4
s_cbranch_scc1 L_h1c4
v_perm_b32 v56, v209, v208, s19
v_perm_b32 v56, v210, v56, s20
v_perm_b32 v56, v211, v56, s21
v_cmp_ne_u32 vcc, s18, v56
s_nop 1
s_cmp_eq_u64 vcc, 0
s_cselect_b32 s0, 16, 0
s_andn2_b32 s4, s4, s0
L_h1c4:
s_bitcmp0_b32 s1, 5
s_cbranch_scc1 L_h1c5
v_perm_b32 v56, v213, v212, s19
v_perm_b32 v56, v214, v56, s20
v_perm_b32 v56, v215, v56, s21
v_cmp_ne_u32 vcc, s18, v56
s_nop 1
s_cmp_eq_u64 vcc, 0
s_cselect_b32 s0, 32, 0
s_andn2_b32 s4, s4, s0
L_h1c5:
s_bitcmp0_b32 s1, 6
s_cbranch_scc1 L_h1c6
v_perm_b32 v56, v217, v216, s19
v_perm_b32 v56, v218, v56, s20
v_perm_b32 v56, v219, v56, s21
v_cmp_ne_u32 vcc, s18, v56
s_nop 1
s_cmp_eq_u64 vcc, 0
s_cselect_b32 s0, 64, 0
s_andn2_b32 s4, s4, s0
L_h1c6:
s_bitcmp0_b32 s1, 7
s_cbranch_scc1 L_h1c7
v_perm_b32 v56, v221, v220, s19
v_perm_b32 v56, v222, v56, s20
v_perm_b32 v56, v223, v56, s21
v_cmp_ne_u32 vcc, s18, v56
s_nop 1
s_cmp_eq_u64 vcc, 0
s_cselect_b32 s0, 128, 0
s_andn2_b32 s4, s4, s0
L_h1c7:
s_cmp_eq_u32 s4, 0
s_cbranch_scc1 L_h1ok
s_sub_u32 s71, s71, 1
s_cmp_eq_u32 s71, 0
s_cbranch_scc1 L_h1ok
v_perm_b32 v56, v93, v92, s19
v_perm_b32 v56, v94, v56, s20
v_cmp_eq_u32 vcc, s22, v56
s_nop 1
s_lshr_b32 s0, vcc_lo, 1
s_and_b32 s0, s0, vcc_lo
s_mov_b32 s1, 0
buffer_load_dwordx3 v[92:94], v48, s[56:59], s6 offen sc1
s_bitcmp0_b32 s4, 0
s_cbranch_scc1 L_h1s0
s_bitcmp0_b32 s0, 0
s_cbranch_scc1 L_h1s0
s_add_u32 s64, s9, 0
buffer_load_dwordx4 v[192:195], v49, s[56:59], s64 offen sc1
s_bitset1_b32 s1, 0
L_h1s0:
s_bitcmp0_b32 s4, 1
s_cbranch_scc1 L_h1s1
s_bitcmp0_b32 s0, 2
s_cbranch_scc1 L_h1s1
s_add_u32 s64, s9, 8192
buffer_load_dwordx4 v[196:199], v49, s[56:59], s64 offen sc1
s_bitset1_b32 s1, 1
L_h1s1:
s_bitcmp0_b32 s4, 2
s_cbranch_scc1 L_h1s2
s_bitcmp0_b32 s0, 4
s_cbranch_scc1 L_h1s2
s_add_u32 s64, s9, 16384
buffer_load_dwordx4 v[200:203], v49, s[56:59], s64 offen sc1
s_bitset1_b32 s1, 2
L_h1s2:
s_bitcmp0_b32 s4, 3
s_cbranch_scc1 L_h1s3
s_bitcmp0_b32 s0, 6
s_cbranch_scc1 L_h1s3
s_add_u32 s64, s9, 24576
buffer_load_dwordx4 v[204:207], v49, s[56:59], s64 offen sc1
s_bitset1_b32 s1, 3
L_h1s3:
s_bitcmp0_b32 s4, 4
s_cbranch_scc1 L_h1s4
s_bitcmp0_b32 s0, 8
s_cbranch_scc1 L_h1s4
s_add_u32 s64, s9, 32768
buffer_load_dwordx4 v[208:211], v49, s[56:59], s64 offen sc1
s_bitset1_b32 s1, 4
L_h1s4:
s_bitcmp0_b32 s4, 5
s_cbranch_scc1 L_h1s5
s_bitcmp0_b32 s0, 10
s_cbranch_scc1 L_h1s5
s_add_u32 s64, s9, 40960
buffer_load_dwordx4 v[212:215], v49, s[56:59], s64 offen sc1
s_bitset1_b32 s1, 5
L_h1s5:
s_bitcmp0_b32 s4, 6
s_cbranch_scc1 L_h1s6
s_bitcmp0_b32 s0, 12
s_cbranch_scc1 L_h1s6
s_add_u32 s64, s9, 49152
buffer_load_dwordx4 v[216:219], v49, s[56:59], s64 offen sc1
s_bitset1_b32 s1, 6
L_h1s6:
s_bitcmp0_b32 s4, 7
s_cbranch_scc1 L_h1s7
s_bitcmp0_b32 s0, 14
s_cbranch_scc1 L_h1s7
s_add_u32 s64, s9, 57344
buffer_load_dwordx4 v[220:223], v49, s[56:59], s64 offen sc1
s_bitset1_b32 s1, 7
L_h1s7:
s_cmp_lg_u32 s1, s4
s_cbranch_scc1 L_h1w
s_cmp_eq_u32 s5, 0
s_cbranch_scc1 L_pf2_1
s_mov_b32 s5, 0
s_mov_b64 exec, 1
buffer_store_dwordx3 v[124:126], v8, s[56:59], s63 offen sc1
s_mov_b64 exec, -1
L_pf2_1:
s_branch L_h1poll
L_h1w:
s_waitcnt vmcnt(0)
s_branch L_h1poll
L_h1ok:
s_cmp_eq_u32 s5, 0
s_cbranch_scc1 L_pf2_2
s_mov_b32 s5, 0
s_mov_b64 exec, 1
buffer_store_dwordx3 v[124:126], v8, s[56:59], s63 offen sc1
s_mov_b64 exec, -1
L_pf2_2:
v_pk_mul_f32 v[60:61], v[192:193], v[72:73] op_sel:[0,0] op_sel_hi:[1,0]
v_pk_mul_f32 v[62:63], v[194:195], v[72:73] op_sel:[0,0] op_sel_hi:[1,0]
v_pk_fma_f32 v[60:61], v[196:197], v[72:73], v[60:61] op_sel:[0,1,0] op_sel_hi:[1,1,1]
v_pk_fma_f32 v[62:63], v[198:199], v[72:73], v[62:63] op_sel:[0,1,0] op_sel_hi:[1,1,1]
v_pk_fma_f32 v[60:61], v[200:201], v[74:75], v[60:61] op_sel:[0,0,0] op_sel_hi:[1,0,1]
v_pk_fma_f32 v[62:63], v[202:203], v[74:75], v[62:63] op_sel:[0,0,0] op_sel_hi:[1,0,1]
v_pk_fma_f32 v[60:61], v[204:205], v[74:75], v[60:61] op_sel:[0,1,0] op_sel_hi:[1,1,1]
v_pk_fma_f32 v[62:63], v[206:207], v[74:75], v[62:63] op_sel:[0,1,0] op_sel_hi:[1,1,1]
v_pk_fma_f32 v[60:61], v[208:209], v[76:77], v[60:61] op_sel:[0,0,0] op_sel_hi:[1,0,1]
v_pk_fma_f32 v[62:63], v[210:211], v[76:77], v[62:63] op_sel:[0,0,0] op_sel_hi:[1,0,1]
v_pk_fma_f32 v[60:61], v[212:213], v[76:77], v[60:61] op_sel:[0,1,0] op_sel_hi:[1,1,1]
v_pk_fma_f32 v[62:63], v[214:215], v[76:77], v[62:63] op_sel:[0,1,0] op_sel_hi:[1,1,1]
v_pk_fma_f32 v[60:61], v[216:217], v[78:79], v[60:61] op_sel:[0,0,0] op_sel_hi:[1,0,1]
v_pk_fma_f32 v[62:63], v[218:219], v[78:79], v[62:63] op_sel:[0,0,0] op_sel_hi:[1,0,1]
v_pk_fma_f32 v[60:61], v[220:221], v[78:79], v[60:61] op_sel:[0,1,0] op_sel_hi:[1,1,1]
v_pk_fma_f32 v[62:63], v[222:223], v[78:79], v[62:63] op_sel:[0,1,0] op_sel_hi:[1,1,1]
v_mov_b32 v64, v60
v_mov_b32 v65, v61
v_mov_b32 v66, v62
v_mov_b32 v67, v63
s_nop 0
v_permlane32_swap_b32 v60, v64
v_permlane32_swap_b32 v61, v65
v_permlane32_swap_b32 v62, v66
v_permlane32_swap_b32 v63, v67
s_nop 0
v_add_f32 v60, v60, v64
v_add_f32 v61, v61, v65
v_add_f32 v62, v62, v66
v_add_f32 v63, v63, v67
v_cvt_pk_bf16_f32 v64, v60, v61
v_cvt_pk_bf16_f32 v65, v62, v63
ds_write_b16 v54, v64 offset:50176
ds_write_b16_d16_hi v54, v64 offset:50192
ds_write_b16 v54, v65 offset:50208
ds_write_b16_d16_hi v54, v65 offset:50224
s_waitcnt lgkmcnt(0)
s_barrier
ds_read_b128 v[56:59], v51 offset:50176
ds_read_b128 v[60:63], v51 offset:50304
s_waitcnt lgkmcnt(0)
v_mfma_f32_16x16x32_bf16 v[128:131], v[224:227], v[56:59], 0
v_mfma_f32_16x16x32_bf16 v[132:135], v[228:231], v[56:59], 0
v_mfma_f32_16x16x32_bf16 v[136:139], v[232:235], v[56:59], 0
v_mfma_f32_16x16x32_bf16 v[140:143], v[236:239], v[56:59], 0
v_mfma_f32_16x16x32_bf16 v[144:147], v[240:243], v[56:59], 0
v_mfma_f32_16x16x32_bf16 v[148:151], v[244:247], v[56:59], 0
v_mfma_f32_16x16x32_bf16 v[152:155], v[248:251], v[56:59], 0
v_mfma_f32_16x16x32_bf16 v[156:159], v[252:255], v[56:59], 0
v_mfma_f32_16x16x32_bf16 v[128:131], v[16:19], v[60:63], v[128:131]
v_mfma_f32_16x16x32_bf16 v[132:135], v[20:23], v[60:63], v[132:135]
v_mfma_f32_16x16x32_bf16 v[136:139], v[24:27], v[60:63], v[136:139]
v_mfma_f32_16x16x32_bf16 v[140:143], v[28:31], v[60:63], v[140:143]
v_mfma_f32_16x16x32_bf16 v[144:147], v[32:35], v[60:63], v[144:147]
v_mfma_f32_16x16x32_bf16 v[148:151], v[36:39], v[60:63], v[148:151]
v_mfma_f32_16x16x32_bf16 v[152:155], v[40:43], v[60:63], v[152:155]
v_mfma_f32_16x16x32_bf16 v[156:159], v[44:47], v[60:63], v[156:159]
s_mov_b32 exec_lo, 0x000f000f
s_mov_b32 exec_hi, 0x00f000f0
ds_write_b128 v52, v[128:131] offset:51200
ds_write_b128 v52, v[132:135] offset:51216
ds_write_b128 v52, v[136:139] offset:51232
ds_write_b128 v52, v[140:143] offset:51248
ds_write_b128 v52, v[144:147] offset:51264
ds_write_b128 v52, v[148:151] offset:51280
s_nop 1
ds_write_b128 v52, v[152:155] offset:51296
ds_write_b128 v52, v[156:159] offset:51312
s_mov_b64 exec, -1
s_waitcnt lgkmcnt(0)
ds_read_b128 v[56:59], v53 offset:51200
ds_read_b128 v[60:63], v53 offset:52288
s_waitcnt lgkmcnt(0)
v_add_f32 v56, v56, v60
v_add_f32 v57, v57, v61
v_add_f32 v58, v58, v62
v_add_f32 v59, v59, v63
v_bfi_b32 v56, v127, s14, v56
v_bfi_b32 v57, v127, s15, v57
v_bfi_b32 v58, v127, s16, v58
v_bfi_b32 v59, v127, s17, v59
buffer_store_dwordx4 v[56:59], v8, s[56:59], s23 offen sc1
s_cmp_lg_u32 s3, 0
s_cbranch_scc1 L_fin
s_and_b32 s67, s2, 128
s_bfe_u32 s68, s2, 0x20005
s_add_u32 s67, s67, s68
s_lshl_b32 s8, s67, 12
s_bfe_u32 s67, s2, 0x20001
s_lshl_b32 s67, s67, 10
s_add_u32 s8, s8, s67
s_bfe_u32 s67, s2, 0x20003
s_lshl_b32 s67, s67, 8
s_add_u32 s8, s8, s67
s_and_b32 s67, s2, 1
s_lshl_b32 s67, s67, 7
s_add_u32 s8, s8, s67
s_add_u32 s8, s8, 4194304
s_and_b32 s9, s2, 0xe0
s_lshl_b32 s9, s9, 4
s_add_u32 s9, s9, 3686400
v_and_b32 v10, 31, v1
v_lshlrev_b32 v10, 4, v10
v_lshrrev_b32 v2, 3, v1
v_lshlrev_b32 v2, 14, v2
v_and_b32 v9, 7, v1
v_lshl_add_u32 v2, v9, 4, v2
s_bfe_u32 s67, s2, 0x20003
s_lshl_b32 s67, s67, 12
s_lshr_b32 s68, s2, 7
s_lshl_b32 s68, s68, 11
s_add_u32 s67, s67, s68
s_bfe_u32 s68, s2, 0x20005
s_lshl_b32 s68, s68, 9
s_add_u32 s67, s67, s68
s_and_b32 s68, s2, 7
s_lshl_b32 s68, s68, 6
s_add_u32 s67, s67, s68
v_lshl_add_u32 v9, v9, 1, s67
s_not_b32 s4, s18
v_mov_b32 v160, s4
v_mov_b32 v164, s4
v_mov_b32 v168, s4
v_mov_b32 v172, s4
s_mov_b32 s71, 1000000
v_mov_b32 v64, s4
L_h2gate:
buffer_load_dwordx3 v[64:66], v10, s[56:59], s9 offen sc1
s_waitcnt vmcnt(3)
v_perm_b32 v68, v65, v64, s19
v_perm_b32 v68, v66, v68, s20
v_cmp_ne_u32 vcc, s22, v68
s_nop 1
s_cmp_eq_u64 vcc, 0
s_cbranch_scc1 L_h2poll
s_sub_u32 s71, s71, 1
s_cmp_lg_u32 s71, 0
s_cbranch_scc1 L_h2gate
L_h2poll:
s_add_u32 s64, s8, 0
buffer_load_dwordx4 v[160:163], v2, s[56:59], s64 offen sc1
s_add_u32 s64, s8, 131072
buffer_load_dwordx4 v[164:167], v2, s[56:59], s64 offen sc1
s_add_u32 s64, s8, 262144
buffer_load_dwordx4 v[168:171], v2, s[56:59], s64 offen sc1
s_add_u32 s64, s8, 393216
buffer_load_dwordx4 v[172:175], v2, s[56:59], s64 offen sc1
s_waitcnt vmcnt(8)
v_perm_b32 v64, v161, v160, s19
v_perm_b32 v64, v162, v64, s20
v_perm_b32 v64, v163, v64, s21
v_xor_b32 v64, s18, v64
v_perm_b32 v65, v165, v164, s19
v_perm_b32 v65, v166, v65, s20
v_perm_b32 v65, v167, v65, s21
v_xor_b32 v65, s18, v65
v_perm_b32 v66, v169, v168, s19
v_perm_b32 v66, v170, v66, s20
v_perm_b32 v66, v171, v66, s21
v_xor_b32 v66, s18, v66
v_perm_b32 v67, v173, v172, s19
v_perm_b32 v67, v174, v67, s20
v_perm_b32 v67, v175, v67, s21
v_xor_b32 v67, s18, v67
v_or3_b32 v64, v64, v65, v66
v_or_b32 v64, v64, v67
v_cmp_ne_u32 vcc, 0, v64
s_nop 1
s_cmp_eq_u64 vcc, 0
s_cbranch_scc1 L_h2ok
s_sub_u32 s71, s71, 1
s_cmp_lg_u32 s71, 0
s_cbranch_scc1 L_h2poll
L_h2ok:
v_add_f32 v224, v160, v164
v_add_f32 v232, v168, v172
v_add_f32 v225, v161, v165
v_add_f32 v233, v169, v173
v_add_f32 v226, v162, v166
v_add_f32 v234, v170, v174
v_add_f32 v227, v163, v167
v_add_f32 v235, v171, v175
v_add_f32 v224, v224, v232
v_add_f32 v225, v225, v233
v_add_f32 v226, v226, v234
v_add_f32 v227, v227, v235
s_nop 0
v_add_f32_dpp v224, v224, v224 row_ror:8 row_mask:0xf bank_mask:0xf
v_add_f32_dpp v225, v225, v225 row_ror:8 row_mask:0xf bank_mask:0xf
v_add_f32_dpp v226, v226, v226 row_ror:8 row_mask:0xf bank_mask:0xf
v_add_f32_dpp v227, v227, v227 row_ror:8 row_mask:0xf bank_mask:0xf
v_mov_b32 v228, v224
v_mov_b32 v229, v225
v_mov_b32 v230, v226
v_mov_b32 v231, v227
s_nop 0
v_permlane16_swap_b32 v224, v228
v_permlane16_swap_b32 v225, v229
v_permlane16_swap_b32 v226, v230
v_permlane16_swap_b32 v227, v231
s_nop 0
v_add_f32 v224, v224, v228
v_add_f32 v225, v225, v229
v_add_f32 v226, v226, v230
v_add_f32 v227, v227, v231
v_mov_b32 v228, v224
v_mov_b32 v229, v225
v_mov_b32 v230, v226
v_mov_b32 v231, v227
s_nop 0
v_permlane32_swap_b32 v224, v228
v_permlane32_swap_b32 v225, v229
v_permlane32_swap_b32 v226, v230
v_permlane32_swap_b32 v227, v231
s_nop 0
v_add_f32 v224, v224, v228
v_add_f32 v225, v225, v229
v_add_f32 v226, v226, v230
v_add_f32 v227, v227, v231
v_cvt_pk_bf16_f32 v228, v224, v225
v_cvt_pk_bf16_f32 v229, v226, v227
s_mov_b64 exec, 0xff
global_store_short v9, v228, s[24:25]
global_store_short_d16_hi v9, v228, s[24:25] offset:16
global_store_short v9, v229, s[24:25] offset:32
global_store_short_d16_hi v9, v229, s[24:25] offset:48
s_endpgm
L_fin:
s_cmp_lg_u32 s2, 0
s_cbranch_scc1 L_nobump
s_cmp_lg_u32 s3, 1
s_cbranch_scc1 L_nobump
v_lshrrev_b32 v2, 5, v1
v_lshlrev_b32 v2, 16, v2
v_and_b32 v9, 31, v1
v_lshl_add_u32 v2, v9, 9, v2
s_mov_b32 s71, 1000000
L_bpoll:
s_mov_b32 s64, 0
buffer_load_dwordx4 v[224:227], v2, s[56:59], s64 offen sc1
s_mov_b32 s64, 131072
buffer_load_dwordx4 v[228:231], v2, s[56:59], s64 offen sc1
s_mov_b32 s64, 262144
buffer_load_dwordx4 v[232:235], v2, s[56:59], s64 offen sc1
s_mov_b32 s64, 393216
buffer_load_dwordx4 v[236:239], v2, s[56:59], s64 offen sc1
s_waitcnt vmcnt(0)
v_perm_b32 v56, v225, v224, s19
v_perm_b32 v56, v226, v56, s20
v_perm_b32 v56, v227, v56, s21
v_xor_b32 v56, s18, v56
v_perm_b32 v57, v229, v228, s19
v_perm_b32 v57, v230, v57, s20
v_perm_b32 v57, v231, v57, s21
v_xor_b32 v57, s18, v57
v_perm_b32 v58, v233, v232, s19
v_perm_b32 v58, v234, v58, s20
v_perm_b32 v58, v235, v58, s21
v_xor_b32 v58, s18, v58
v_perm_b32 v59, v237, v236, s19
v_perm_b32 v59, v238, v59, s20
v_perm_b32 v59, v239, v59, s21
v_xor_b32 v59, s18, v59
v_or3_b32 v56, v56, v57, v58
v_or_b32 v56, v56, v59
v_cmp_ne_u32 vcc, 0, v56
s_nop 1
s_cmp_eq_u64 vcc, 0
s_cbranch_scc1 L_bok
s_sub_u32 s71, s71, 1
s_cmp_lg_u32 s71, 0
s_cbranch_scc1 L_bpoll
L_bok:
s_add_u32 s11, s11, 1
v_mov_b32 v56, s11
v_mov_b32 v57, 0
s_mov_b64 exec, 1
global_store_dword v57, v56, s[12:13]
s_mov_b64 exec, -1
L_nobump:
L_done:
s_endpgm
.fill (4*4096 + 64 - (. - concat_heads__gqa_block_cached__sliding_block_cached__decode_kernel))/4, 4, 0xbf800000
.section .rodata,"a"
.p2align 6
.amdhsa_kernel concat_heads__gqa_block_cached__sliding_block_cached__decode_kernel
  .amdhsa_next_free_vgpr 512
  .amdhsa_next_free_sgpr 102
  .amdhsa_accum_offset 256
  .amdhsa_group_segment_fixed_size 0
  .amdhsa_kernarg_size 104
  .amdhsa_user_sgpr_count 2
  .amdhsa_user_sgpr_kernarg_segment_ptr 1
  .amdhsa_system_sgpr_workgroup_id_x 1
.end_amdhsa_kernel
```
